```python
import torch

def _softmax(x, axis=-1):
    return torch.softmax(x, dim=axis)
def _gelu(x):
    return torch.nn.functional.gelu(x, approximate="tanh")
def _silu(x):
    return torch.nn.functional.silu(x)
def _sigmoid(x):
    return torch.sigmoid(x)
def _layernorm(x, axis=-1, eps=1e-5):
    m = x.mean(dim=axis, keepdim=True)
    v = x.var(dim=axis, keepdim=True, unbiased=False)
    return (x - m) / torch.sqrt(v + eps)
def _scatter_add(tgt, idx, src, axis=0):
    return tgt.clone().index_add_(axis, idx, src)
def _segment_sum(src, seg, n):
    out = torch.zeros((n,) + src.shape[1:], dtype=src.dtype)
    return out.index_add_(0, seg, src)
def _pad(x, pw):
    flat = tuple(v for pair in reversed(pw) for v in pair)
    return torch.nn.functional.pad(x, flat)

kernel_name = 'recurrent_scan__compressed_kv_cla__glu_gated_reglu__decode'

def setup_inputs():

    _w = (lambda a: (lambda t: t.to(torch.bfloat16) if t.is_floating_point() else t)(torch.as_tensor(a)))
    def _A_setup():
        B, H, Sq, Sk, D, M = 2, 32, 1, 8192, 128, 512
        Dc = 4 * D
        return {
            "x": _w((lambda *s: torch.randn(*s, dtype=torch.bfloat16) * 0.05)(B, Sq, M)),
            "c_kv": _w((lambda *s: torch.randn(*s, dtype=torch.bfloat16) * 1.6)(B, Sk, Dc)),
            "w_q": _w((lambda *s: torch.randn(*s, dtype=torch.bfloat16) * 1.6)(M, H, D) * (M ** -0.5)),
            "w_uk": _w((lambda *s: torch.randn(*s, dtype=torch.bfloat16) * 1.6)(Dc, H, D) * (Dc ** -0.5)),
            "w_uv": _w((lambda *s: torch.randn(*s, dtype=torch.bfloat16) * 1.6)(Dc, H, D) * (Dc ** -0.5)),
            "w_o": _w((lambda *s: torch.randn(*s, dtype=torch.bfloat16) * 1.6)(H, D, M) * ((H * D) ** -0.5)),
        }
    _A_in = _A_setup()

    def _B_setup():
        B, S, D, F = 2, 1, 512, 1792
        return {
            "x": _w((lambda *s: torch.randn(*s, dtype=torch.bfloat16) * 0.05)(B, S, D)),
            "W_gate": _w((lambda *s: torch.randn(*s, dtype=torch.bfloat16) * 0.2)(D, F) * (2.0 / D) ** 0.5),
            "W_up": _w((lambda *s: torch.randn(*s, dtype=torch.bfloat16) * 0.2)(D, F) * (2.0 / D) ** 0.5),
            "W_down": _w((lambda *s: torch.randn(*s, dtype=torch.bfloat16) * 0.2)(F, D) * (1.0 / F) ** 0.5),
        }
    _B_in = _B_setup()

    return {
        "A_x": _A_in["x"],
        "A_c_kv": _A_in["c_kv"],
        "A_w_q": _A_in["w_q"],
        "A_w_uk": _A_in["w_uk"],
        "A_w_uv": _A_in["w_uv"],
        "A_w_o": _A_in["w_o"],
        "B_x": _B_in["x"],
        "B_W_gate": _B_in["W_gate"],
        "B_W_up": _B_in["W_up"],
        "B_W_down": _B_in["W_down"],
    }

def reference(A_x, A_c_kv, A_w_q, A_w_uk, A_w_uv, A_w_o, B_x, B_W_gate, B_W_up, B_W_down):
    def _A_ref(x, c_kv, w_q, w_uk, w_uv, w_o):
        B, Sq, M = x.shape[0], x.shape[1], x.shape[2]
        Sk = c_kv.shape[1]
        H, D = w_q.shape[1], w_q.shape[2]
        q = torch.einsum("bqm,mhd->bhqd", x, w_q)
        k = torch.einsum("bkc,chd->bhkd", c_kv, w_uk)
        v = torch.einsum("bkc,chd->bhkd", c_kv, w_uv)
        scores = torch.einsum("bhqd,bhkd->bhqk", q, k) * (D ** -0.5)
        off = Sk - Sq
        qi = torch.arange(Sq)[:, None]
        kj = torch.arange(Sk)[None, :]
        cmask = kj <= (qi + off)
        scores = torch.where(cmask[None, None], scores, -1e9)
        p = _softmax(scores, axis=-1)
        ctx = torch.einsum("bhqk,bhkd->bhqd", p, v)
        return torch.einsum("bhqd,hdm->bqm", ctx, w_o)

    def _B_ref(x, W_gate, W_up, W_down):
        gate = torch.einsum("bsd,df->bsf", x, W_gate)
        up = torch.einsum("bsd,df->bsf", x, W_up)
        gate = gate * (lambda x, dt: x.to(dt))(gate > 0, gate.dtype)
        h = gate * up
        return torch.einsum("bsf,fd->bsd", h, W_down)

    x = A_x
    xn = _layernorm(x, axis=-1)
    s = _A_ref(xn, A_c_kv, A_w_q, A_w_uk, A_w_uv, A_w_o)
    g = _silu(_B_ref(xn, B_W_gate, B_W_up, B_W_down))
    return x + s * g
```

```asm
; @launch grid=(256,1,1) block=(512,1,1) lds=163840
.amdgcn_target "amdgcn-amd-amdhsa--gfx950"
.text
.globl recurrent_scan__compressed_kv_cla__glu_gated_reglu__decode_kernel
.p2align 8
.type recurrent_scan__compressed_kv_cla__glu_gated_reglu__decode_kernel,@function
recurrent_scan__compressed_kv_cla__glu_gated_reglu__decode_kernel:
  s_cmp_ge_u32 s2, 256
  s_cbranch_scc1 L_end
  s_load_dwordx16 s[4:19], s[0:1], 0
  s_load_dwordx8 s[20:27], s[0:1], 64
  s_load_dwordx2 s[28:29], s[0:1], 96
  v_lshrrev_b32 v2, 6, v0
  v_and_b32 v1, 63, v0
  s_and_b32 s45, s2, 7
  s_bfe_u32 s46, s2, 0x10003
  s_lshr_b32 s47, s2, 4
  v_readfirstlane_b32 s44, v2
  s_lshr_b32 s48, s47, 2
  s_lshl_b32 s54, s45, 2
  s_add_u32 s48, s48, s54
  s_and_b32 s49, s47, 3
  s_lshl_b32 s50, s49, 1
  s_add_u32 s50, s50, s46
  s_lshr_b32 s52, s47, 3
  s_and_b32 s53, s47, 7
  s_lshl_b32 s53, s53, 3
  s_add_u32 s53, s53, s45
  s_lshl_b32 s61, s48, 2
  s_add_u32 s61, s61, s49
  v_and_b32 v2, 15, v1
  v_lshrrev_b32 v3, 4, v1
  s_and_b32 s74, s44, 1
  s_lshl_b32 s74, s74, 10
  v_lshlrev_b32 v24, 4, v1
  v_lshlrev_b32 v25, 1, v3
  v_xor_b32 v25, v25, v2
  v_lshlrev_b32 v25, 4, v25
  v_lshl_add_u32 v25, v3, 13, v25
  v_xor_b32 v26, 128, v25
  s_lshl_b32 s54, s49, 7
  s_lshl_b32 s55, s44, 4
  s_add_u32 s54, s54, s55
  s_lshl_b32 s54, s54, 13
  s_lshl_b32 s55, s48, 8
  s_add_u32 s66, s54, s55
  s_lshl_b32 s56, s44, 12
  s_mov_b32 s38, 2048
  s_mov_b32 s39, 0x20000
  s_mov_b32 s42, 4194304
  s_mov_b32 s43, 0x20000
  s_mov_b32 s34, 268435456
  s_mov_b32 s35, 0x20000
  s_waitcnt lgkmcnt(0)
  s_load_dword s51, s[28:29], 0
  s_mov_b32 s32, s28
  s_mov_b32 s33, s29
  s_cmp_eq_u32 s46, 0
  s_cbranch_scc0 L_kv
  s_mov_b32 s36, s4
  s_mov_b32 s37, s5
  buffer_load_dwordx4 v[4:7], v24, s[36:39], s74 offen
  s_mov_b32 s40, s8
  s_mov_b32 s41, s9
  s_add_u32 s57, s66, 0
  s_add_u32 m0, s56, 0
  s_nop 0
  buffer_load_dwordx4 v25, s[40:43], s57 offen nt lds
  s_add_u32 s57, s66, 32768
  s_add_u32 m0, s56, 1024
  s_nop 0
  buffer_load_dwordx4 v25, s[40:43], s57 offen nt lds
  s_add_u32 s57, s66, 65536
  s_add_u32 m0, s56, 2048
  s_nop 0
  buffer_load_dwordx4 v26, s[40:43], s57 offen nt lds
  s_add_u32 s57, s66, 98304
  s_add_u32 m0, s56, 3072
  s_nop 0
  buffer_load_dwordx4 v26, s[40:43], s57 offen nt lds
  s_barrier
  s_mov_b32 s36, s10
  s_mov_b32 s37, s11
  s_mov_b32 s38, 4194304
  s_mov_b32 s39, 0x20000
  v_xor_b32 v27, v3, v2
  v_xor_b32 v28, 0, v27
  v_lshlrev_b32 v28, 4, v28
  v_lshl_add_u32 v28, v3, 13, v28
  s_add_u32 s57, s66, 0
  s_add_u32 m0, s56, 32768
  s_nop 0
  buffer_load_dwordx4 v28, s[36:39], s57 offen nt lds
  v_xor_b32 v28, 4, v27
  v_lshlrev_b32 v28, 4, v28
  v_lshl_add_u32 v28, v3, 13, v28
  s_add_u32 s57, s66, 32768
  s_add_u32 m0, s56, 33792
  s_nop 0
  buffer_load_dwordx4 v28, s[36:39], s57 offen nt lds
  v_xor_b32 v28, 8, v27
  v_lshlrev_b32 v28, 4, v28
  v_lshl_add_u32 v28, v3, 13, v28
  s_add_u32 s57, s66, 65536
  s_add_u32 m0, s56, 34816
  s_nop 0
  buffer_load_dwordx4 v28, s[36:39], s57 offen nt lds
  v_xor_b32 v28, 12, v27
  v_lshlrev_b32 v28, 4, v28
  v_lshl_add_u32 v28, v3, 13, v28
  s_add_u32 s57, s66, 98304
  s_add_u32 m0, s56, 35840
  s_nop 0
  buffer_load_dwordx4 v28, s[36:39], s57 offen nt lds
  s_cmp_lt_u32 s44, 2
  s_cbranch_scc0 L_skip_1
  s_waitcnt vmcnt(8)
  v_lshlrev_b32 v36, 16, v4
  v_and_b32 v37, 0xffff0000, v4
  v_lshlrev_b32 v38, 16, v5
  v_and_b32 v39, 0xffff0000, v5
  v_lshlrev_b32 v40, 16, v6
  v_and_b32 v41, 0xffff0000, v6
  v_lshlrev_b32 v42, 16, v7
  v_and_b32 v43, 0xffff0000, v7
  v_add_f32 v44, v36, v37
  v_add_f32 v44, v44, v38
  v_add_f32 v44, v44, v39
  v_add_f32 v44, v44, v40
  v_add_f32 v44, v44, v41
  v_add_f32 v44, v44, v42
  v_add_f32 v44, v44, v43
  s_nop 1
  v_add_f32_dpp v44, v44, v44 row_ror:8 row_mask:0xf bank_mask:0xf
  s_nop 1
  v_add_f32_dpp v44, v44, v44 row_ror:4 row_mask:0xf bank_mask:0xf
  s_nop 1
  v_add_f32_dpp v44, v44, v44 row_ror:2 row_mask:0xf bank_mask:0xf
  s_nop 1
  v_add_f32_dpp v44, v44, v44 row_ror:1 row_mask:0xf bank_mask:0xf
  v_mov_b32 v45, v44
  s_nop 1
  v_permlane16_swap_b32 v44, v45
  v_add_f32 v44, v44, v45
  v_mov_b32 v45, v44
  s_nop 1
  v_permlane32_swap_b32 v44, v45
  v_add_f32 v44, v44, v45
  v_mul_f32 v44, 0.001953125, v44
  v_sub_f32 v36, v36, v44
  v_sub_f32 v37, v37, v44
  v_sub_f32 v38, v38, v44
  v_sub_f32 v39, v39, v44
  v_sub_f32 v40, v40, v44
  v_sub_f32 v41, v41, v44
  v_sub_f32 v42, v42, v44
  v_sub_f32 v43, v43, v44
  v_mul_f32 v46, v36, v36
  v_fmac_f32 v46, v37, v37
  v_fmac_f32 v46, v38, v38
  v_fmac_f32 v46, v39, v39
  v_fmac_f32 v46, v40, v40
  v_fmac_f32 v46, v41, v41
  v_fmac_f32 v46, v42, v42
  v_fmac_f32 v46, v43, v43
  s_nop 1
  v_add_f32_dpp v46, v46, v46 row_ror:8 row_mask:0xf bank_mask:0xf
  s_nop 1
  v_add_f32_dpp v46, v46, v46 row_ror:4 row_mask:0xf bank_mask:0xf
  s_nop 1
  v_add_f32_dpp v46, v46, v46 row_ror:2 row_mask:0xf bank_mask:0xf
  s_nop 1
  v_add_f32_dpp v46, v46, v46 row_ror:1 row_mask:0xf bank_mask:0xf
  v_mov_b32 v45, v46
  s_nop 1
  v_permlane16_swap_b32 v46, v45
  v_add_f32 v46, v46, v45
  v_mov_b32 v45, v46
  s_nop 1
  v_permlane32_swap_b32 v46, v45
  v_add_f32 v46, v46, v45
  v_mov_b32 v47, 0x3727c5ac
  v_fmac_f32 v47, 0.001953125, v46
  v_rsq_f32 v47, v47
  s_nop 0
  v_mul_f32 v36, v36, v47
  v_mul_f32 v37, v37, v47
  v_mul_f32 v38, v38, v47
  v_mul_f32 v39, v39, v47
  v_mul_f32 v40, v40, v47
  v_mul_f32 v41, v41, v47
  v_mul_f32 v42, v42, v47
  v_mul_f32 v43, v43, v47
  v_cvt_pk_bf16_f32 v48, v36, v37
  v_cvt_pk_bf16_f32 v49, v38, v39
  v_cvt_pk_bf16_f32 v50, v40, v41
  v_cvt_pk_bf16_f32 v51, v42, v43
  s_lshl_b32 s54, s44, 10
  v_lshlrev_b32 v52, 4, v1
  v_add_u32 v52, s54, v52
  v_add_u32 v52, 131072, v52
  ds_write_b128 v52, v[48:51]
L_skip_1:
  v_lshrrev_b32 v36, 2, v2
  v_and_b32 v37, 3, v2
  v_lshlrev_b32 v38, 1, v36
  v_and_b32 v39, 1, v3
  v_lshl_add_u32 v38, v39, 3, v38
  v_lshrrev_b32 v39, 1, v37
  s_lshl_b32 s54, s44, 1
  v_add_u32 v39, s54, v39
  v_xor_b32 v39, v39, v38
  v_lshlrev_b32 v39, 4, v39
  v_and_b32 v37, 1, v37
  v_lshl_add_u32 v39, v37, 3, v39
  v_lshl_add_u32 v36, v3, 3, v36
  v_lshl_add_u32 v34, v36, 8, v39
  v_and_b32 v36, 1, v1
  v_lshlrev_b32 v36, 10, v36
  v_lshl_add_u32 v36, v3, 4, v36
  v_add_u32 v35, 131072, v36
  s_lshl_b32 s54, s49, 8
  v_add_u32 v80, s54, v35
  v_lshlrev_b32 v81, 9, v2
  v_lshl_add_u32 v81, v3, 4, v81
  s_lshl_b32 s54, s48, 12
  s_lshl_b32 s55, s49, 10
  s_add_u32 s54, s54, s55
  s_lshl_b32 s55, s44, 6
  s_add_u32 s54, s54, s55
  s_add_u32 s67, s54, 65536
  v_xor_b32 v82, v3, v2
  v_lshlrev_b32 v82, 4, v82
  v_lshl_add_u32 v82, v2, 8, v82
  s_lshl_b32 s54, s44, 12
  s_add_u32 s54, s54, 32768
  v_add_u32 v82, s54, v82
  s_lshl_b32 s54, s48, 12
  s_lshl_b32 s55, s44, 10
  s_add_u32 s54, s54, s55
  s_add_u32 s68, s54, 65536
  v_lshlrev_b32 v83, 4, v1
  v_lshrrev_b32 v84, 5, v1
  s_lshl_b32 s55, s44, 1
  v_add_u32 v84, s55, v84
  v_mul_u32_u24 v84, 272, v84
  v_and_b32 v39, 31, v1
  v_lshl_add_u32 v84, v39, 3, v84
  v_add_u32 v84, 148480, v84
  v_and_b32 v85, 7, v2
  v_mul_u32_u24 v85, 272, v85
  v_lshl_add_u32 v85, v3, 4, v85
  v_add_u32 v85, 148480, v85
  v_lshlrev_b32 v86, 8, v2
  v_lshl_add_u32 v86, v3, 3, v86
  s_lshl_b32 s54, s44, 5
  v_add_u32 v86, s54, v86
  v_add_u32 v86, 151552, v86
  v_add_u32 v87, 151552, v83
  s_lshl_b32 s54, s48, 10
  s_lshl_b32 s55, s49, 8
  s_add_u32 s54, s54, s55
  s_add_u32 s69, s54, 262144
  v_lshlrev_b32 v88, 15, v3
  v_lshl_add_u32 v88, v2, 4, v88
  s_waitcnt lgkmcnt(0)
  s_mul_i32 s51, s51, 1103515245
  s_add_u32 s51, s51, 0x9E3779B9
  s_lshr_b32 s76, s51, 8
  s_lshr_b32 s77, s51, 16
  s_lshr_b32 s78, s51, 24
  s_mov_b32 s79, 0xfffefffe
  v_mov_b32 v248, 0xff
  v_and_b32 v36, 3, v1
  v_lshlrev_b32 v250, 3, v36
  v_mov_b32 v251, s51
  v_lshrrev_b32 v250, v250, v251
  v_bfe_u32 v251, v250, 1, 1
  v_bfe_u32 v244, v250, 0, 1
  v_lshl_or_b32 v244, v251, 16, v244
  v_bfe_u32 v251, v250, 3, 1
  v_bfe_u32 v245, v250, 2, 1
  v_lshl_or_b32 v245, v251, 16, v245
  v_bfe_u32 v251, v250, 5, 1
  v_bfe_u32 v246, v250, 4, 1
  v_lshl_or_b32 v246, v251, 16, v246
  v_bfe_u32 v251, v250, 7, 1
  v_bfe_u32 v247, v250, 6, 1
  v_lshl_or_b32 v247, v251, 16, v247
  v_mov_b32 v78, s51
  v_mov_b32 v79, s51
  s_waitcnt vmcnt(4)
  s_barrier
  ds_read_b64_tr_b16 v[40:41], v34 offset:0
  ds_read_b64_tr_b16 v[42:43], v34 offset:1024
  ds_read_b128 v[56:59], v80 offset:0
  ds_read_b64_tr_b16 v[44:45], v34 offset:8192
  ds_read_b64_tr_b16 v[46:47], v34 offset:9216
  ds_read_b128 v[60:63], v80 offset:64
  ds_read_b64_tr_b16 v[48:49], v34 offset:16384
  ds_read_b64_tr_b16 v[50:51], v34 offset:17408
  ds_read_b128 v[64:67], v80 offset:128
  ds_read_b64_tr_b16 v[52:53], v34 offset:24576
  ds_read_b64_tr_b16 v[54:55], v34 offset:25600
  ds_read_b128 v[68:71], v80 offset:192
  s_waitcnt lgkmcnt(9)
  v_mfma_f32_16x16x32_bf16 v[72:75], v[40:43], v[56:59], 0
  s_waitcnt lgkmcnt(6)
  v_mfma_f32_16x16x32_bf16 v[72:75], v[44:47], v[60:63], v[72:75]
  s_waitcnt lgkmcnt(3)
  v_mfma_f32_16x16x32_bf16 v[72:75], v[48:51], v[64:67], v[72:75]
  s_waitcnt lgkmcnt(0)
  v_mfma_f32_16x16x32_bf16 v[72:75], v[52:55], v[68:71], v[72:75]
  v_cmp_gt_u32 vcc, 2, v2
  s_nop 6
  v_cvt_pk_bf16_f32 v76, v72, v73
  v_cvt_pk_bf16_f32 v77, v74, v75
  s_and_saveexec_b64 s[62:63], vcc
  buffer_store_dwordx4 v[76:79], v81, s[32:35], s67 offen sc1
  s_mov_b64 exec, s[62:63]
  s_waitcnt vmcnt(1)
  v_xor_b32 v40, 0, v82
  ds_read_b128 v[8:11], v40
  v_xor_b32 v40, 64, v82
  ds_read_b128 v[12:15], v40
  v_xor_b32 v40, 128, v82
  ds_read_b128 v[16:19], v40
  v_xor_b32 v40, 192, v82
  ds_read_b128 v[20:23], v40
  s_cmp_lt_u32 s44, 4
  s_cbranch_scc0 L_skip_2
  s_mov_b32 s60, 20000
  s_mov_b64 s[62:63], exec
L_h1_3:
  s_sleep 6
  buffer_load_dwordx4 v[40:43], v83, s[32:35], s68 offen sc1
  s_waitcnt vmcnt(0)
  v_cmp_ne_u32 vcc, s51, v42
  s_nop 0
  s_and_b64 vcc, vcc, exec
  s_cbranch_vccz L_done_4
  s_sub_u32 s60, s60, 1
  s_cbranch_scc1 L_done_4
  s_mov_b64 exec, vcc
  s_branch L_h1_3
L_done_4:
  s_mov_b64 exec, s[62:63]
  ds_write_b64 v84, v[40:41]
L_skip_2:
  s_waitcnt lgkmcnt(0)
  s_barrier
  ds_read_b128 v[40:43], v85 offset:0
  ds_read_b128 v[48:51], v85 offset:64
  ds_read_b128 v[56:59], v85 offset:128
  ds_read_b128 v[64:67], v85 offset:192
  s_waitcnt lgkmcnt(3)
  v_mfma_f32_16x16x32_bf16 v[72:75], v[8:11], v[40:43], 0
  s_waitcnt lgkmcnt(2)
  v_mfma_f32_16x16x32_bf16 v[72:75], v[12:15], v[48:51], v[72:75]
  s_waitcnt lgkmcnt(1)
  v_mfma_f32_16x16x32_bf16 v[72:75], v[16:19], v[56:59], v[72:75]
  s_waitcnt lgkmcnt(0)
  v_mfma_f32_16x16x32_bf16 v[72:75], v[20:23], v[64:67], v[72:75]
  s_nop 7
  v_add_f32_dpp v72, v72, v72 row_ror:4 row_mask:0xf bank_mask:0xf
  v_add_f32_dpp v73, v73, v73 row_ror:4 row_mask:0xf bank_mask:0xf
  v_add_f32_dpp v74, v74, v74 row_ror:4 row_mask:0xf bank_mask:0xf
  v_add_f32_dpp v75, v75, v75 row_ror:4 row_mask:0xf bank_mask:0xf
  v_add_f32_dpp v72, v72, v72 row_ror:2 row_mask:0xf bank_mask:0xf
  v_add_f32_dpp v73, v73, v73 row_ror:2 row_mask:0xf bank_mask:0xf
  v_add_f32_dpp v74, v74, v74 row_ror:2 row_mask:0xf bank_mask:0xf
  v_add_f32_dpp v75, v75, v75 row_ror:2 row_mask:0xf bank_mask:0xf
  v_mul_f32 v72, 0x3e0293ee, v72
  v_mul_f32 v73, 0x3e0293ee, v73
  v_mul_f32 v74, 0x3e0293ee, v74
  v_mul_f32 v75, 0x3e0293ee, v75
  v_cmp_gt_u32 vcc, 2, v2
  v_cvt_pk_bf16_f32 v76, v72, v73
  v_cvt_pk_bf16_f32 v77, v74, v75
  s_and_saveexec_b64 s[62:63], vcc
  ds_write_b64 v86, v[76:77]
  s_mov_b64 exec, s[62:63]
  s_waitcnt lgkmcnt(0)
  s_barrier
  s_cmp_eq_u32 s44, 0
  s_cbranch_scc0 L_skip_5
  v_cmp_gt_u32 vcc, 32, v1
  ds_read_b128 v[40:43], v87
  s_waitcnt lgkmcnt(0)
  v_and_or_b32 v40, v40, s79, v244
  v_and_or_b32 v41, v41, s79, v245
  v_and_or_b32 v42, v42, s79, v246
  v_and_or_b32 v43, v43, s79, v247
  s_and_saveexec_b64 s[62:63], vcc
  buffer_store_dwordx4 v[40:43], v88, s[32:35], s69 offen sc1
  s_mov_b64 exec, s[62:63]
L_skip_5:
  s_lshl_b32 s56, s61, 7
  s_add_u32 s56, s56, 32768
  s_mov_b32 s60, 20000
  v_mov_b32 v255, 0
L_wp_6:
  buffer_load_dword v254, v255, s[32:35], s56 offen sc1
  s_waitcnt vmcnt(0)
  v_cmp_ne_u32 vcc, s51, v254
  s_nop 0
  s_and_b64 vcc, vcc, exec
  s_cbranch_vccz L_wdone_7
  s_sub_u32 s60, s60, 1
  s_cbranch_scc1 L_wdone_7
  s_sleep 8
  s_branch L_wp_6
L_wdone_7:
  s_mov_b32 s36, s12
  s_mov_b32 s37, s13
  s_mov_b32 s38, 4194304
  s_mov_b32 s39, 0x20000
  v_lshlrev_b32 v4, 1, v3
  v_xor_b32 v4, v4, v2
  v_lshlrev_b32 v4, 4, v4
  v_lshl_add_u32 v4, v3, 13, v4
  v_xor_b32 v5, 128, v4
  s_lshl_b32 s56, s44, 12
  s_add_u32 s57, s66, 0
  s_add_u32 m0, s56, 0
  s_nop 0
  buffer_load_dwordx4 v4, s[36:39], s57 offen nt lds
  s_add_u32 s57, s66, 32768
  s_add_u32 m0, s56, 1024
  s_nop 0
  buffer_load_dwordx4 v4, s[36:39], s57 offen nt lds
  s_add_u32 s57, s66, 65536
  s_add_u32 m0, s56, 2048
  s_nop 0
  buffer_load_dwordx4 v5, s[36:39], s57 offen nt lds
  s_add_u32 s57, s66, 98304
  s_add_u32 m0, s56, 3072
  s_nop 0
  buffer_load_dwordx4 v5, s[36:39], s57 offen nt lds
  s_mov_b32 s40, s14
  s_mov_b32 s41, s15
  s_mov_b32 s42, 4194304
  s_mov_b32 s43, 0x20000
  v_lshlrev_b32 v48, 1, v3
  v_xor_b32 v48, v48, v2
  v_lshlrev_b32 v48, 4, v48
  v_lshl_add_u32 v91, v3, 10, v48
  v_xor_b32 v48, 128, v91
  s_lshl_b32 s54, s48, 7
  s_lshl_b32 s55, s44, 4
  s_add_u32 s54, s54, s55
  s_lshl_b32 s71, s54, 10
  s_add_u32 s58, s49, 0
  s_and_b32 s58, s58, 3
  s_lshl_b32 s59, s58, 8
  s_add_u32 s59, s59, s71
  s_lshl_b32 s56, s44, 12
  s_add_u32 s57, s59, 0
  s_add_u32 m0, s56, 98304
  s_nop 0
  buffer_load_dwordx4 v91, s[40:43], s57 offen  lds
  s_add_u32 s57, s59, 4096
  s_add_u32 m0, s56, 99328
  s_nop 0
  buffer_load_dwordx4 v91, s[40:43], s57 offen  lds
  s_add_u32 s57, s59, 8192
  s_add_u32 m0, s56, 100352
  s_nop 0
  buffer_load_dwordx4 v48, s[40:43], s57 offen  lds
  s_add_u32 s57, s59, 12288
  s_add_u32 m0, s56, 101376
  s_nop 0
  buffer_load_dwordx4 v48, s[40:43], s57 offen  lds
  s_add_u32 s58, s49, 1
  s_and_b32 s58, s58, 3
  s_lshl_b32 s59, s58, 8
  s_add_u32 s59, s59, s71
  s_lshl_b32 s56, s44, 12
  s_add_u32 s57, s59, 0
  s_add_u32 m0, s56, 65536
  s_nop 0
  buffer_load_dwordx4 v91, s[40:43], s57 offen  lds
  s_add_u32 s57, s59, 4096
  s_add_u32 m0, s56, 66560
  s_nop 0
  buffer_load_dwordx4 v91, s[40:43], s57 offen  lds
  s_add_u32 s57, s59, 8192
  s_add_u32 m0, s56, 67584
  s_nop 0
  buffer_load_dwordx4 v48, s[40:43], s57 offen  lds
  s_add_u32 s57, s59, 12288
  s_add_u32 m0, s56, 68608
  s_nop 0
  buffer_load_dwordx4 v48, s[40:43], s57 offen  lds
  s_add_u32 s58, s49, 2
  s_and_b32 s58, s58, 3
  s_lshl_b32 s59, s58, 8
  s_add_u32 s59, s59, s71
  s_lshl_b32 s56, s44, 12
  s_add_u32 s57, s59, 0
  s_add_u32 m0, s56, 32768
  s_nop 0
  buffer_load_dwordx4 v91, s[40:43], s57 offen  lds
  s_add_u32 s57, s59, 4096
  s_add_u32 m0, s56, 33792
  s_nop 0
  buffer_load_dwordx4 v91, s[40:43], s57 offen  lds
  s_add_u32 s57, s59, 8192
  s_add_u32 m0, s56, 34816
  s_nop 0
  buffer_load_dwordx4 v48, s[40:43], s57 offen  lds
  s_add_u32 s57, s59, 12288
  s_add_u32 m0, s56, 35840
  s_nop 0
  buffer_load_dwordx4 v48, s[40:43], s57 offen  lds
  s_waitcnt vmcnt(12)
  s_barrier
  ds_read_b64_tr_b16 v[8:9], v34 offset:0
  ds_read_b64_tr_b16 v[10:11], v34 offset:1024
  ds_read_b64_tr_b16 v[12:13], v34 offset:8192
  ds_read_b64_tr_b16 v[14:15], v34 offset:9216
  ds_read_b64_tr_b16 v[16:17], v34 offset:16384
  ds_read_b64_tr_b16 v[18:19], v34 offset:17408
  ds_read_b64_tr_b16 v[20:21], v34 offset:24576
  ds_read_b64_tr_b16 v[22:23], v34 offset:25600
  s_waitcnt lgkmcnt(0)
  s_barrier
  s_add_u32 s58, s49, 3
  s_and_b32 s58, s58, 3
  s_lshl_b32 s59, s58, 8
  s_add_u32 s59, s59, s71
  s_lshl_b32 s56, s44, 12
  s_add_u32 s57, s59, 0
  s_add_u32 m0, s56, 0
  s_nop 0
  buffer_load_dwordx4 v91, s[40:43], s57 offen  lds
  s_add_u32 s57, s59, 4096
  s_add_u32 m0, s56, 1024
  s_nop 0
  buffer_load_dwordx4 v91, s[40:43], s57 offen  lds
  s_add_u32 s57, s59, 8192
  s_add_u32 m0, s56, 2048
  s_nop 0
  buffer_load_dwordx4 v48, s[40:43], s57 offen  lds
  s_add_u32 s57, s59, 12288
  s_add_u32 m0, s56, 3072
  s_nop 0
  buffer_load_dwordx4 v48, s[40:43], s57 offen  lds
  s_branch L_tail
L_kv:
  s_cmp_lt_u32 s47, 1
  s_cbranch_scc0 L_ncp_8
  s_getpc_b64 s[64:65]
L_pcref:
  s_sub_u32 s64, s64, L_pcref-recurrent_scan__compressed_kv_cla__glu_gated_reglu__decode_kernel
  s_subb_u32 s65, s65, 0
  v_lshlrev_b32 v4, 4, v0
  global_load_dwordx4 v[40:43], v4, s[64:65]
  v_add_u32 v4, 8192, v4
  v_cmp_gt_u32 vcc, L_end-recurrent_scan__compressed_kv_cla__glu_gated_reglu__decode_kernel-16, v4
  s_nop 0
  s_and_saveexec_b64 s[62:63], vcc
  s_cbranch_execz L_ncq_9
  global_load_dwordx4 v[40:43], v4, s[64:65]
L_ncq_9:
  s_mov_b64 exec, s[62:63]
L_ncp_8:
  s_lshl_b32 s61, s47, 3
  s_add_u32 s61, s61, s45
  s_lshr_b32 s48, s61, 2
  s_and_b32 s49, s61, 3
  s_mov_b32 s36, s4
  s_mov_b32 s37, s5
  s_mov_b32 s38, 2048
  s_mov_b32 s39, 0x20000
  v_lshlrev_b32 v4, 4, v1
  buffer_load_dwordx4 v[40:43], v4, s[36:39], 0 offen
  buffer_load_dwordx4 v[44:47], v4, s[36:39], 0 offen offset:1024
  v_and_b32 v5, 1, v1
  v_lshlrev_b32 v5, 10, v5
  v_lshl_add_u32 v5, v3, 4, v5
  s_lshl_b32 s54, s49, 8
  buffer_load_dwordx4 v[56:59], v5, s[36:39], s54 offen offset:0
  buffer_load_dwordx4 v[60:63], v5, s[36:39], s54 offen offset:64
  buffer_load_dwordx4 v[64:67], v5, s[36:39], s54 offen offset:128
  buffer_load_dwordx4 v[68:71], v5, s[36:39], s54 offen offset:192
  s_mov_b32 s36, s6
  s_mov_b32 s37, s7
  s_mov_b32 s38, 16777216
  s_mov_b32 s39, 0x20000
  s_lshl_b32 s54, s52, 23
  s_lshl_b32 s55, s53, 17
  s_add_u32 s54, s54, s55
  s_lshl_b32 s55, s44, 14
  s_add_u32 s54, s54, s55
  v_lshlrev_b32 v4, 4, v1
  v_xor_b32 v5, 0, v4
  s_add_u32 s57, s54, 0
  s_add_u32 m0, s55, 0
  s_nop 0
  buffer_load_dwordx4 v5, s[36:39], s57 offen nt lds
  v_xor_b32 v5, 64, v4
  s_add_u32 s57, s54, 1024
  s_add_u32 m0, s55, 1024
  s_nop 0
  buffer_load_dwordx4 v5, s[36:39], s57 offen nt lds
  v_xor_b32 v5, 128, v4
  s_add_u32 s57, s54, 2048
  s_add_u32 m0, s55, 2048
  s_nop 0
  buffer_load_dwordx4 v5, s[36:39], s57 offen nt lds
  v_xor_b32 v5, 192, v4
  s_add_u32 s57, s54, 3072
  s_add_u32 m0, s55, 3072
  s_nop 0
  buffer_load_dwordx4 v5, s[36:39], s57 offen nt lds
  v_xor_b32 v5, 16, v4
  s_add_u32 s57, s54, 4096
  s_add_u32 m0, s55, 4096
  s_nop 0
  buffer_load_dwordx4 v5, s[36:39], s57 offen nt lds
  v_xor_b32 v5, 80, v4
  s_add_u32 s57, s54, 5120
  s_add_u32 m0, s55, 5120
  s_nop 0
  buffer_load_dwordx4 v5, s[36:39], s57 offen nt lds
  v_xor_b32 v5, 144, v4
  s_add_u32 s57, s54, 6144
  s_add_u32 m0, s55, 6144
  s_nop 0
  buffer_load_dwordx4 v5, s[36:39], s57 offen nt lds
  v_xor_b32 v5, 208, v4
  s_add_u32 s57, s54, 7168
  s_add_u32 m0, s55, 7168
  s_nop 0
  buffer_load_dwordx4 v5, s[36:39], s57 offen nt lds
  v_xor_b32 v5, 32, v4
  s_add_u32 s57, s54, 8192
  s_add_u32 m0, s55, 8192
  s_nop 0
  buffer_load_dwordx4 v5, s[36:39], s57 offen nt lds
  v_xor_b32 v5, 96, v4
  s_add_u32 s57, s54, 9216
  s_add_u32 m0, s55, 9216
  s_nop 0
  buffer_load_dwordx4 v5, s[36:39], s57 offen nt lds
  v_xor_b32 v5, 160, v4
  s_add_u32 s57, s54, 10240
  s_add_u32 m0, s55, 10240
  s_nop 0
  buffer_load_dwordx4 v5, s[36:39], s57 offen nt lds
  v_xor_b32 v5, 224, v4
  s_add_u32 s57, s54, 11264
  s_add_u32 m0, s55, 11264
  s_nop 0
  buffer_load_dwordx4 v5, s[36:39], s57 offen nt lds
  v_xor_b32 v5, 48, v4
  s_add_u32 s57, s54, 12288
  s_add_u32 m0, s55, 12288
  s_nop 0
  buffer_load_dwordx4 v5, s[36:39], s57 offen nt lds
  v_xor_b32 v5, 112, v4
  s_add_u32 s57, s54, 13312
  s_add_u32 m0, s55, 13312
  s_nop 0
  buffer_load_dwordx4 v5, s[36:39], s57 offen nt lds
  v_xor_b32 v5, 176, v4
  s_add_u32 s57, s54, 14336
  s_add_u32 m0, s55, 14336
  s_nop 0
  buffer_load_dwordx4 v5, s[36:39], s57 offen nt lds
  v_xor_b32 v5, 240, v4
  s_add_u32 s57, s54, 15360
  s_add_u32 m0, s55, 15360
  s_nop 0
  buffer_load_dwordx4 v5, s[36:39], s57 offen nt lds
  s_waitcnt vmcnt(16)
  v_lshlrev_b32 v48, 16, v40
  v_and_b32 v49, 0xffff0000, v40
  v_lshlrev_b32 v50, 16, v41
  v_and_b32 v51, 0xffff0000, v41
  v_lshlrev_b32 v52, 16, v42
  v_and_b32 v53, 0xffff0000, v42
  v_lshlrev_b32 v54, 16, v43
  v_and_b32 v55, 0xffff0000, v43
  v_add_f32 v4, v48, v49
  v_add_f32 v4, v4, v50
  v_add_f32 v4, v4, v51
  v_add_f32 v4, v4, v52
  v_add_f32 v4, v4, v53
  v_add_f32 v4, v4, v54
  v_add_f32 v4, v4, v55
  s_nop 1
  v_add_f32_dpp v4, v4, v4 row_ror:8 row_mask:0xf bank_mask:0xf
  s_nop 1
  v_add_f32_dpp v4, v4, v4 row_ror:4 row_mask:0xf bank_mask:0xf
  s_nop 1
  v_add_f32_dpp v4, v4, v4 row_ror:2 row_mask:0xf bank_mask:0xf
  s_nop 1
  v_add_f32_dpp v4, v4, v4 row_ror:1 row_mask:0xf bank_mask:0xf
  v_mov_b32 v5, v4
  s_nop 1
  v_permlane16_swap_b32 v4, v5
  v_add_f32 v4, v4, v5
  v_mov_b32 v5, v4
  s_nop 1
  v_permlane32_swap_b32 v4, v5
  v_add_f32 v4, v4, v5
  v_mul_f32 v6, 0.001953125, v4
  v_sub_f32 v48, v48, v6
  v_sub_f32 v49, v49, v6
  v_sub_f32 v50, v50, v6
  v_sub_f32 v51, v51, v6
  v_sub_f32 v52, v52, v6
  v_sub_f32 v53, v53, v6
  v_sub_f32 v54, v54, v6
  v_sub_f32 v55, v55, v6
  v_mul_f32 v4, v48, v48
  v_fmac_f32 v4, v49, v49
  v_fmac_f32 v4, v50, v50
  v_fmac_f32 v4, v51, v51
  v_fmac_f32 v4, v52, v52
  v_fmac_f32 v4, v53, v53
  v_fmac_f32 v4, v54, v54
  v_fmac_f32 v4, v55, v55
  s_nop 1
  v_add_f32_dpp v4, v4, v4 row_ror:8 row_mask:0xf bank_mask:0xf
  s_nop 1
  v_add_f32_dpp v4, v4, v4 row_ror:4 row_mask:0xf bank_mask:0xf
  s_nop 1
  v_add_f32_dpp v4, v4, v4 row_ror:2 row_mask:0xf bank_mask:0xf
  s_nop 1
  v_add_f32_dpp v4, v4, v4 row_ror:1 row_mask:0xf bank_mask:0xf
  v_mov_b32 v5, v4
  s_nop 1
  v_permlane16_swap_b32 v4, v5
  v_add_f32 v4, v4, v5
  v_mov_b32 v5, v4
  s_nop 1
  v_permlane32_swap_b32 v4, v5
  v_add_f32 v4, v4, v5
  v_mov_b32 v5, 0x3727c5ac
  v_fmac_f32 v5, 0.001953125, v4
  v_rsq_f32 v7, v5
  v_lshlrev_b32 v48, 16, v44
  v_and_b32 v49, 0xffff0000, v44
  v_lshlrev_b32 v50, 16, v45
  v_and_b32 v51, 0xffff0000, v45
  v_lshlrev_b32 v52, 16, v46
  v_and_b32 v53, 0xffff0000, v46
  v_lshlrev_b32 v54, 16, v47
  v_and_b32 v55, 0xffff0000, v47
  v_add_f32 v4, v48, v49
  v_add_f32 v4, v4, v50
  v_add_f32 v4, v4, v51
  v_add_f32 v4, v4, v52
  v_add_f32 v4, v4, v53
  v_add_f32 v4, v4, v54
  v_add_f32 v4, v4, v55
  s_nop 1
  v_add_f32_dpp v4, v4, v4 row_ror:8 row_mask:0xf bank_mask:0xf
  s_nop 1
  v_add_f32_dpp v4, v4, v4 row_ror:4 row_mask:0xf bank_mask:0xf
  s_nop 1
  v_add_f32_dpp v4, v4, v4 row_ror:2 row_mask:0xf bank_mask:0xf
  s_nop 1
  v_add_f32_dpp v4, v4, v4 row_ror:1 row_mask:0xf bank_mask:0xf
  v_mov_b32 v5, v4
  s_nop 1
  v_permlane16_swap_b32 v4, v5
  v_add_f32 v4, v4, v5
  v_mov_b32 v5, v4
  s_nop 1
  v_permlane32_swap_b32 v4, v5
  v_add_f32 v4, v4, v5
  v_mul_f32 v250, 0.001953125, v4
  v_sub_f32 v48, v48, v250
  v_sub_f32 v49, v49, v250
  v_sub_f32 v50, v50, v250
  v_sub_f32 v51, v51, v250
  v_sub_f32 v52, v52, v250
  v_sub_f32 v53, v53, v250
  v_sub_f32 v54, v54, v250
  v_sub_f32 v55, v55, v250
  v_mul_f32 v4, v48, v48
  v_fmac_f32 v4, v49, v49
  v_fmac_f32 v4, v50, v50
  v_fmac_f32 v4, v51, v51
  v_fmac_f32 v4, v52, v52
  v_fmac_f32 v4, v53, v53
  v_fmac_f32 v4, v54, v54
  v_fmac_f32 v4, v55, v55
  s_nop 1
  v_add_f32_dpp v4, v4, v4 row_ror:8 row_mask:0xf bank_mask:0xf
  s_nop 1
  v_add_f32_dpp v4, v4, v4 row_ror:4 row_mask:0xf bank_mask:0xf
  s_nop 1
  v_add_f32_dpp v4, v4, v4 row_ror:2 row_mask:0xf bank_mask:0xf
  s_nop 1
  v_add_f32_dpp v4, v4, v4 row_ror:1 row_mask:0xf bank_mask:0xf
  v_mov_b32 v5, v4
  s_nop 1
  v_permlane16_swap_b32 v4, v5
  v_add_f32 v4, v4, v5
  v_mov_b32 v5, v4
  s_nop 1
  v_permlane32_swap_b32 v4, v5
  v_add_f32 v4, v4, v5
  v_mov_b32 v5, 0x3727c5ac
  v_fmac_f32 v5, 0.001953125, v4
  v_rsq_f32 v251, v5
  v_and_b32 v4, 1, v1
  v_cmp_eq_u32 vcc, 1, v4
  s_nop 1
  v_cndmask_b32 v6, v6, v250, vcc
  v_cndmask_b32 v7, v7, v251, vcc
  v_lshlrev_b32 v4, 16, v56
  v_and_b32 v5, 0xffff0000, v56
  v_sub_f32 v4, v4, v6
  v_sub_f32 v5, v5, v6
  v_mul_f32 v4, v4, v7
  v_mul_f32 v5, v5, v7
  v_cvt_pk_bf16_f32 v200, v4, v5
  v_lshlrev_b32 v4, 16, v57
  v_and_b32 v5, 0xffff0000, v57
  v_sub_f32 v4, v4, v6
  v_sub_f32 v5, v5, v6
  v_mul_f32 v4, v4, v7
  v_mul_f32 v5, v5, v7
  v_cvt_pk_bf16_f32 v201, v4, v5
  v_lshlrev_b32 v4, 16, v58
  v_and_b32 v5, 0xffff0000, v58
  v_sub_f32 v4, v4, v6
  v_sub_f32 v5, v5, v6
  v_mul_f32 v4, v4, v7
  v_mul_f32 v5, v5, v7
  v_cvt_pk_bf16_f32 v202, v4, v5
  v_lshlrev_b32 v4, 16, v59
  v_and_b32 v5, 0xffff0000, v59
  v_sub_f32 v4, v4, v6
  v_sub_f32 v5, v5, v6
  v_mul_f32 v4, v4, v7
  v_mul_f32 v5, v5, v7
  v_cvt_pk_bf16_f32 v203, v4, v5
  v_lshlrev_b32 v4, 16, v60
  v_and_b32 v5, 0xffff0000, v60
  v_sub_f32 v4, v4, v6
  v_sub_f32 v5, v5, v6
  v_mul_f32 v4, v4, v7
  v_mul_f32 v5, v5, v7
  v_cvt_pk_bf16_f32 v204, v4, v5
  v_lshlrev_b32 v4, 16, v61
  v_and_b32 v5, 0xffff0000, v61
  v_sub_f32 v4, v4, v6
  v_sub_f32 v5, v5, v6
  v_mul_f32 v4, v4, v7
  v_mul_f32 v5, v5, v7
  v_cvt_pk_bf16_f32 v205, v4, v5
  v_lshlrev_b32 v4, 16, v62
  v_and_b32 v5, 0xffff0000, v62
  v_sub_f32 v4, v4, v6
  v_sub_f32 v5, v5, v6
  v_mul_f32 v4, v4, v7
  v_mul_f32 v5, v5, v7
  v_cvt_pk_bf16_f32 v206, v4, v5
  v_lshlrev_b32 v4, 16, v63
  v_and_b32 v5, 0xffff0000, v63
  v_sub_f32 v4, v4, v6
  v_sub_f32 v5, v5, v6
  v_mul_f32 v4, v4, v7
  v_mul_f32 v5, v5, v7
  v_cvt_pk_bf16_f32 v207, v4, v5
  v_lshlrev_b32 v4, 16, v64
  v_and_b32 v5, 0xffff0000, v64
  v_sub_f32 v4, v4, v6
  v_sub_f32 v5, v5, v6
  v_mul_f32 v4, v4, v7
  v_mul_f32 v5, v5, v7
  v_cvt_pk_bf16_f32 v216, v4, v5
  v_lshlrev_b32 v4, 16, v65
  v_and_b32 v5, 0xffff0000, v65
  v_sub_f32 v4, v4, v6
  v_sub_f32 v5, v5, v6
  v_mul_f32 v4, v4, v7
  v_mul_f32 v5, v5, v7
  v_cvt_pk_bf16_f32 v217, v4, v5
  v_lshlrev_b32 v4, 16, v66
  v_and_b32 v5, 0xffff0000, v66
  v_sub_f32 v4, v4, v6
  v_sub_f32 v5, v5, v6
  v_mul_f32 v4, v4, v7
  v_mul_f32 v5, v5, v7
  v_cvt_pk_bf16_f32 v218, v4, v5
  v_lshlrev_b32 v4, 16, v67
  v_and_b32 v5, 0xffff0000, v67
  v_sub_f32 v4, v4, v6
  v_sub_f32 v5, v5, v6
  v_mul_f32 v4, v4, v7
  v_mul_f32 v5, v5, v7
  v_cvt_pk_bf16_f32 v219, v4, v5
  v_lshlrev_b32 v4, 16, v68
  v_and_b32 v5, 0xffff0000, v68
  v_sub_f32 v4, v4, v6
  v_sub_f32 v5, v5, v6
  v_mul_f32 v4, v4, v7
  v_mul_f32 v5, v5, v7
  v_cvt_pk_bf16_f32 v220, v4, v5
  v_lshlrev_b32 v4, 16, v69
  v_and_b32 v5, 0xffff0000, v69
  v_sub_f32 v4, v4, v6
  v_sub_f32 v5, v5, v6
  v_mul_f32 v4, v4, v7
  v_mul_f32 v5, v5, v7
  v_cvt_pk_bf16_f32 v221, v4, v5
  v_lshlrev_b32 v4, 16, v70
  v_and_b32 v5, 0xffff0000, v70
  v_sub_f32 v4, v4, v6
  v_sub_f32 v5, v5, v6
  v_mul_f32 v4, v4, v7
  v_mul_f32 v5, v5, v7
  v_cvt_pk_bf16_f32 v222, v4, v5
  v_lshlrev_b32 v4, 16, v71
  v_and_b32 v5, 0xffff0000, v71
  v_sub_f32 v4, v4, v6
  v_sub_f32 v5, v5, v6
  v_mul_f32 v4, v4, v7
  v_mul_f32 v5, v5, v7
  v_cvt_pk_bf16_f32 v223, v4, v5
  v_and_b32 v4, 3, v1
  v_lshlrev_b32 v4, 2, v4
  v_bfe_u32 v5, v1, 2, 2
  v_or_b32 v4, v4, v5
  v_lshrrev_b32 v5, 5, v1
  v_xor_b32 v4, v4, v5
  v_lshlrev_b32 v4, 4, v4
  v_and_b32 v5, 31, v1
  v_lshl_add_u32 v4, v5, 10, v4
  s_and_b32 s54, s44, 3
  s_lshl_b32 s54, s54, 15
  v_xor_b32 v16, 0, v4
  v_add_u32 v8, s54, v16
  v_add_u32 v16, 131072, v16
  v_xor_b32 v17, 32, v4
  v_add_u32 v9, s54, v17
  v_add_u32 v17, 131072, v17
  v_xor_b32 v18, 64, v4
  v_add_u32 v10, s54, v18
  v_add_u32 v18, 131072, v18
  v_xor_b32 v19, 96, v4
  v_add_u32 v11, s54, v19
  v_add_u32 v19, 131072, v19
  v_xor_b32 v20, 128, v4
  v_add_u32 v12, s54, v20
  v_add_u32 v20, 131072, v20
  v_xor_b32 v21, 160, v4
  v_add_u32 v13, s54, v21
  v_add_u32 v21, 131072, v21
  v_xor_b32 v22, 192, v4
  v_add_u32 v14, s54, v22
  v_add_u32 v22, 131072, v22
  v_xor_b32 v23, 224, v4
  v_add_u32 v15, s54, v23
  v_add_u32 v23, 131072, v23
  v_lshrrev_b32 v4, 2, v2
  v_and_b32 v5, 3, v2
  v_lshlrev_b32 v6, 1, v3
  v_and_b32 v6, 3, v6
  v_lshl_or_b32 v6, v4, 2, v6
  s_and_b32 s54, s44, 1
  s_lshl_b32 s54, s54, 3
  v_lshrrev_b32 v7, 1, v5
  v_or_b32 v7, s54, v7
  v_xor_b32 v7, v7, v6
  v_lshlrev_b32 v7, 4, v7
  v_and_b32 v5, 1, v5
  v_lshl_add_u32 v7, v5, 3, v7
  v_lshl_add_u32 v5, v3, 3, v4
  v_lshl_add_u32 v7, v5, 10, v7
  s_lshr_b32 s54, s44, 1
  s_lshl_b32 s54, s54, 8
  v_add_u32 v7, s54, v7
  v_xor_b32 v24, 0, v7
  v_xor_b32 v25, 16, v7
  v_xor_b32 v26, 32, v7
  v_xor_b32 v27, 48, v7
  v_xor_b32 v28, 64, v7
  v_xor_b32 v29, 80, v7
  v_xor_b32 v30, 96, v7
  v_xor_b32 v31, 112, v7
  s_and_b32 s54, s44, 3
  v_xor_b32 v36, s54, v1
  v_xor_b32 v32, 0, v36
  v_lshlrev_b32 v32, 4, v32
  v_xor_b32 v33, 4, v36
  v_lshlrev_b32 v33, 4, v33
  v_xor_b32 v34, 8, v36
  v_lshlrev_b32 v34, 4, v34
  v_xor_b32 v35, 12, v36
  v_lshlrev_b32 v35, 4, v35
  s_lshl_b32 s54, s52, 15
  s_lshl_b32 s55, s44, 12
  s_add_u32 s54, s54, s55
  s_add_u32 s66, s54, 262144
  s_add_u32 s67, s66, 1024
  s_add_u32 s68, s66, 2048
  s_add_u32 s69, s66, 3072
  s_lshl_b32 s70, s44, 12
  s_add_u32 s70, s70, 131072
  v_lshlrev_b32 v37, 4, v1
  v_add_u32 v37, s70, v37
  s_and_b32 s54, s44, 3
  s_lshl_b32 s54, s54, 15
  v_and_b32 v5, 31, v1
  v_lshlrev_b32 v209, 2, v5
  v_add_u32 v208, s54, v209
  v_mul_u32_u24 v5, 80, v5
  v_lshrrev_b32 v6, 5, v1
  v_lshl_add_u32 v5, v6, 3, v5
  v_add_u32 v5, s54, v5
  v_add_u32 v210, 1024, v5
  v_mul_u32_u24 v5, 80, v2
  v_lshl_add_u32 v5, v3, 4, v5
  v_add_u32 v211, 1024, v5
  v_add_u32 v212, 66560, v5
  s_lshr_b32 s55, s44, 2
  s_mul_i32 s55, s55, 4608
  s_add_u32 s56, s54, s55
  s_add_u32 s56, s56, 4608
  v_mul_u32_u24 v4, 144, v2
  v_lshl_add_u32 v4, v3, 3, v4
  v_add_u32 v213, s56, v4
  v_lshrrev_b32 v5, 3, v1
  v_and_b32 v6, 7, v1
  v_mul_u32_u24 v7, 144, v5
  v_lshl_add_u32 v7, v6, 4, v7
  v_add_u32 v214, s56, v7
  v_lshlrev_b32 v5, 17, v5
  v_lshl_add_u32 v215, v6, 4, v5
  s_lshr_b32 s54, s44, 1
  s_lshl_b32 s54, s54, 15
  s_lshl_b32 s55, s52, 14
  s_add_u32 s54, s54, s55
  s_and_b32 s55, s44, 1
  s_lshl_b32 s55, s55, 7
  s_add_u32 s54, s54, s55
  s_lshl_b32 s55, s53, 8
  s_add_u32 s54, s54, s55
  s_add_u32 s71, s54, 2097152
  s_add_u32 s72, s71, 1048576
  s_add_u32 s73, s71, 2097152
  s_add_u32 s74, s71, 3145728
  v_and_b32 v249, 31, v1
  v_lshlrev_b32 v249, 11, v249
  s_lshl_b32 s54, s52, 10
  s_lshl_b32 s55, s53, 4
  s_add_u32 s54, s54, s55
  s_add_u32 s75, s54, 393216
  s_waitcnt lgkmcnt(0)
  s_mul_i32 s51, s51, 1103515245
  s_add_u32 s51, s51, 0x9E3779B9
  s_lshr_b32 s76, s51, 8
  s_lshr_b32 s77, s51, 16
  s_lshr_b32 s78, s51, 24
  s_mov_b32 s79, 0xfffefffe
  v_mov_b32 v248, 0xff
  v_and_b32 v38, 3, v1
  v_lshlrev_b32 v250, 3, v38
  v_mov_b32 v251, s51
  v_lshrrev_b32 v250, v250, v251
  v_bfe_u32 v251, v250, 1, 1
  v_bfe_u32 v244, v250, 0, 1
  v_lshl_or_b32 v244, v251, 16, v244
  v_bfe_u32 v251, v250, 3, 1
  v_bfe_u32 v245, v250, 2, 1
  v_lshl_or_b32 v245, v251, 16, v245
  v_bfe_u32 v251, v250, 5, 1
  v_bfe_u32 v246, v250, 4, 1
  v_lshl_or_b32 v246, v251, 16, v246
  v_bfe_u32 v251, v250, 7, 1
  v_bfe_u32 v247, v250, 6, 1
  v_lshl_or_b32 v247, v251, 16, v247
  v_mov_b32 v240, v244
  v_mov_b32 v241, v245
  v_mov_b32 v242, v246
  v_mov_b32 v243, v247
  v_and_b32 v36, 3, v36
  v_lshlrev_b32 v250, 3, v36
  v_mov_b32 v251, s51
  v_lshrrev_b32 v250, v250, v251
  v_bfe_u32 v251, v250, 1, 1
  v_bfe_u32 v244, v250, 0, 1
  v_lshl_or_b32 v244, v251, 16, v244
  v_bfe_u32 v251, v250, 3, 1
  v_bfe_u32 v245, v250, 2, 1
  v_lshl_or_b32 v245, v251, 16, v245
  v_bfe_u32 v251, v250, 5, 1
  v_bfe_u32 v246, v250, 4, 1
  v_lshl_or_b32 v246, v251, 16, v246
  v_bfe_u32 v251, v250, 7, 1
  v_bfe_u32 v247, v250, 6, 1
  v_lshl_or_b32 v247, v251, 16, v247
  v_lshrrev_b32 v38, 4, v1
  v_lshlrev_b32 v38, 10, v38
  v_bfe_u32 v39, v1, 2, 2
  v_lshl_add_u32 v38, v39, 8, v38
  v_lshl_add_u32 v38, v36, 4, v38
  s_mov_b32 s59, s66
  s_cmp_eq_u32 s44, 2
  s_cbranch_scc0 L_skip_10
  s_waitcnt vmcnt(0)
  v_mov_b32 v4, s51
  v_mov_b32 v5, 0
  s_lshl_b32 s54, s47, 3
  s_add_u32 s54, s54, s45
  s_lshl_b32 s54, s54, 7
  s_add_u32 s54, s54, 32768
  v_cmp_eq_u32 vcc, 0, v1
  s_nop 0
  s_and_saveexec_b64 s[62:63], vcc
  buffer_store_dword v4, v5, s[32:35], s54 offen sc1
  s_mov_b64 exec, s[62:63]
L_skip_10:
  s_waitcnt vmcnt(0)
  s_barrier
  s_add_u32 m0, s70, 0
  s_nop 0
  buffer_load_dwordx4 v32, s[32:35], s66 offen sc1 lds
  s_add_u32 m0, s70, 1024
  s_nop 0
  buffer_load_dwordx4 v33, s[32:35], s67 offen sc1 lds
  s_add_u32 m0, s70, 2048
  s_nop 0
  buffer_load_dwordx4 v34, s[32:35], s68 offen sc1 lds
  s_add_u32 m0, s70, 3072
  s_nop 0
  buffer_load_dwordx4 v35, s[32:35], s69 offen sc1 lds
  s_mov_b32 s64, 0
  ds_read_b64_tr_b16 v[72:73], v24 offset:0
  ds_read_b64_tr_b16 v[74:75], v25 offset:4096
  ds_read_b64_tr_b16 v[88:89], v26 offset:0
  ds_read_b64_tr_b16 v[90:91], v27 offset:4096
  ds_read_b64_tr_b16 v[104:105], v28 offset:0
  ds_read_b64_tr_b16 v[106:107], v29 offset:4096
  ds_read_b64_tr_b16 v[120:121], v30 offset:0
  ds_read_b64_tr_b16 v[122:123], v31 offset:4096
  ds_read_b64_tr_b16 v[76:77], v24 offset:32768
  ds_read_b64_tr_b16 v[78:79], v25 offset:36864
  ds_read_b64_tr_b16 v[92:93], v26 offset:32768
  ds_read_b64_tr_b16 v[94:95], v27 offset:36864
  ds_read_b64_tr_b16 v[108:109], v28 offset:32768
  ds_read_b64_tr_b16 v[110:111], v29 offset:36864
  ds_read_b64_tr_b16 v[124:125], v30 offset:32768
  ds_read_b64_tr_b16 v[126:127], v31 offset:36864
  v_add_u32 v24, 0x10000, v24
  v_add_u32 v25, 0x10000, v25
  v_add_u32 v26, 0x10000, v26
  v_add_u32 v27, 0x10000, v27
  v_add_u32 v28, 0x10000, v28
  v_add_u32 v29, 0x10000, v29
  v_add_u32 v30, 0x10000, v30
  v_add_u32 v31, 0x10000, v31
  ds_read_b64_tr_b16 v[80:81], v24 offset:0
  ds_read_b64_tr_b16 v[82:83], v25 offset:4096
  ds_read_b64_tr_b16 v[96:97], v26 offset:0
  ds_read_b64_tr_b16 v[98:99], v27 offset:4096
  ds_read_b64_tr_b16 v[112:113], v28 offset:0
  ds_read_b64_tr_b16 v[114:115], v29 offset:4096
  ds_read_b64_tr_b16 v[128:129], v30 offset:0
  ds_read_b64_tr_b16 v[130:131], v31 offset:4096
  ds_read_b64_tr_b16 v[84:85], v24 offset:32768
  ds_read_b64_tr_b16 v[86:87], v25 offset:36864
  ds_read_b64_tr_b16 v[100:101], v26 offset:32768
  ds_read_b64_tr_b16 v[102:103], v27 offset:36864
  ds_read_b64_tr_b16 v[116:117], v28 offset:32768
  ds_read_b64_tr_b16 v[118:119], v29 offset:36864
  ds_read_b64_tr_b16 v[132:133], v30 offset:32768
  ds_read_b64_tr_b16 v[134:135], v31 offset:36864
  s_mov_b32 s60, 20000
  s_branch L_h2c_13
L_h2_11:
  s_add_u32 m0, s70, 0
  s_nop 0
  buffer_load_dwordx4 v32, s[32:35], s66 offen sc1 lds
  s_add_u32 m0, s70, 1024
  s_nop 0
  buffer_load_dwordx4 v33, s[32:35], s67 offen sc1 lds
  s_add_u32 m0, s70, 2048
  s_nop 0
  buffer_load_dwordx4 v34, s[32:35], s68 offen sc1 lds
  s_add_u32 m0, s70, 3072
  s_nop 0
  buffer_load_dwordx4 v35, s[32:35], s69 offen sc1 lds
  s_waitcnt vmcnt(0)
  s_branch L_h2r_14
L_h2c_13:
  s_cmp_eq_u32 s64, 1
  s_cbranch_scc1 L_w12_15
  s_waitcnt vmcnt(0)
  s_branch L_h2r_14
L_w12_15:
  s_waitcnt vmcnt(8)
L_h2r_14:
  ds_read_b128 v[40:43], v37 offset:0
  ds_read_b128 v[44:47], v37 offset:1024
  ds_read_b128 v[48:51], v37 offset:2048
  ds_read_b128 v[52:55], v37 offset:3072
  s_waitcnt lgkmcnt(0)
  v_xor_b32 v252, v40, v244
  v_xor_b32 v253, v41, v245
  v_or_b32 v56, v252, v253
  v_xor_b32 v252, v42, v246
  v_xor_b32 v253, v43, v247
  v_or3_b32 v56, v56, v252, v253
  v_xor_b32 v252, v44, v244
  v_xor_b32 v253, v45, v245
  v_or3_b32 v56, v56, v252, v253
  v_xor_b32 v252, v46, v246
  v_xor_b32 v253, v47, v247
  v_or3_b32 v56, v56, v252, v253
  v_xor_b32 v252, v48, v244
  v_xor_b32 v253, v49, v245
  v_or3_b32 v56, v56, v252, v253
  v_xor_b32 v252, v50, v246
  v_xor_b32 v253, v51, v247
  v_or3_b32 v56, v56, v252, v253
  v_xor_b32 v252, v52, v244
  v_xor_b32 v253, v53, v245
  v_or3_b32 v56, v56, v252, v253
  v_xor_b32 v252, v54, v246
  v_xor_b32 v253, v55, v247
  v_or3_b32 v56, v56, v252, v253
  v_and_b32 v56, 0x10001, v56
  s_nop 1
  v_or_b32_dpp v56, v56, v56 quad_perm:[1,0,3,2] row_mask:0xf bank_mask:0xf
  s_nop 1
  v_or_b32_dpp v56, v56, v56 quad_perm:[2,3,0,1] row_mask:0xf bank_mask:0xf
  v_cmp_ne_u32 vcc, 0, v56
  s_nop 0
  s_and_b64 vcc, vcc, exec
  s_cbranch_vccz L_h2d_12
  s_sub_u32 s60, s60, 1
  s_cbranch_scc1 L_h2d_12
  s_sleep 2
  s_branch L_h2_11
L_h2d_12:
  s_barrier
  s_cmp_lt_u32 s44, 4
  s_cbranch_scc0 L_pvonly_16
  ds_read_b128 v[136:139], v8 offset:0
  ds_read_b128 v[140:143], v16 offset:0
  ds_read_b128 v[144:147], v9 offset:0
  ds_read_b128 v[148:151], v17 offset:0
  ds_read_b128 v[152:155], v10 offset:0
  ds_read_b128 v[156:159], v18 offset:0
  ds_read_b128 v[160:163], v11 offset:0
  ds_read_b128 v[164:167], v19 offset:0
  ds_read_b128 v[168:171], v12 offset:0
  ds_read_b128 v[172:175], v20 offset:0
  ds_read_b128 v[176:179], v13 offset:0
  ds_read_b128 v[180:183], v21 offset:0
  s_waitcnt lgkmcnt(10)
  v_mfma_f32_32x32x16_bf16 v[184:199], v[136:139], v[140:143], 0
  ds_read_b128 v[136:139], v14 offset:0
  ds_read_b128 v[140:143], v22 offset:0
  s_waitcnt lgkmcnt(10)
  v_mfma_f32_32x32x16_bf16 v[184:199], v[144:147], v[148:151], v[184:199]
  ds_read_b128 v[144:147], v15 offset:0
  ds_read_b128 v[148:151], v23 offset:0
  s_waitcnt lgkmcnt(10)
  v_mfma_f32_32x32x16_bf16 v[184:199], v[152:155], v[156:159], v[184:199]
  ds_read_b128 v[152:155], v8 offset:256
  ds_read_b128 v[156:159], v16 offset:256
  s_waitcnt lgkmcnt(10)
  v_mfma_f32_32x32x16_bf16 v[184:199], v[160:163], v[164:167], v[184:199]
  ds_read_b128 v[160:163], v9 offset:256
  ds_read_b128 v[164:167], v17 offset:256
  s_waitcnt lgkmcnt(10)
  v_mfma_f32_32x32x16_bf16 v[184:199], v[168:171], v[172:175], v[184:199]
  ds_read_b128 v[168:171], v10 offset:256
  ds_read_b128 v[172:175], v18 offset:256
  s_waitcnt lgkmcnt(10)
  v_mfma_f32_32x32x16_bf16 v[184:199], v[176:179], v[180:183], v[184:199]
  ds_read_b128 v[176:179], v11 offset:256
  ds_read_b128 v[180:183], v19 offset:256
  s_waitcnt lgkmcnt(10)
  v_mfma_f32_32x32x16_bf16 v[184:199], v[136:139], v[140:143], v[184:199]
  ds_read_b128 v[136:139], v12 offset:256
  ds_read_b128 v[140:143], v20 offset:256
  s_waitcnt lgkmcnt(10)
  v_mfma_f32_32x32x16_bf16 v[184:199], v[144:147], v[148:151], v[184:199]
  ds_read_b128 v[144:147], v13 offset:256
  ds_read_b128 v[148:151], v21 offset:256
  s_waitcnt lgkmcnt(10)
  v_mfma_f32_32x32x16_bf16 v[184:199], v[152:155], v[156:159], v[184:199]
  ds_read_b128 v[152:155], v14 offset:256
  ds_read_b128 v[156:159], v22 offset:256
  s_waitcnt lgkmcnt(10)
  v_mfma_f32_32x32x16_bf16 v[184:199], v[160:163], v[164:167], v[184:199]
  ds_read_b128 v[160:163], v15 offset:256
  ds_read_b128 v[164:167], v23 offset:256
  s_waitcnt lgkmcnt(10)
  v_mfma_f32_32x32x16_bf16 v[184:199], v[168:171], v[172:175], v[184:199]
  ds_read_b128 v[168:171], v8 offset:512
  ds_read_b128 v[172:175], v16 offset:512
  s_waitcnt lgkmcnt(10)
  v_mfma_f32_32x32x16_bf16 v[184:199], v[176:179], v[180:183], v[184:199]
  ds_read_b128 v[176:179], v9 offset:512
  ds_read_b128 v[180:183], v17 offset:512
  s_waitcnt lgkmcnt(10)
  v_mfma_f32_32x32x16_bf16 v[184:199], v[136:139], v[140:143], v[184:199]
  ds_read_b128 v[136:139], v10 offset:512
  ds_read_b128 v[140:143], v18 offset:512
  s_waitcnt lgkmcnt(10)
  v_mfma_f32_32x32x16_bf16 v[184:199], v[144:147], v[148:151], v[184:199]
  ds_read_b128 v[144:147], v11 offset:512
  ds_read_b128 v[148:151], v19 offset:512
  s_waitcnt lgkmcnt(10)
  v_mfma_f32_32x32x16_bf16 v[184:199], v[152:155], v[156:159], v[184:199]
  ds_read_b128 v[152:155], v12 offset:512
  ds_read_b128 v[156:159], v20 offset:512
  s_waitcnt lgkmcnt(10)
  v_mfma_f32_32x32x16_bf16 v[184:199], v[160:163], v[164:167], v[184:199]
  ds_read_b128 v[160:163], v13 offset:512
  ds_read_b128 v[164:167], v21 offset:512
  s_waitcnt lgkmcnt(10)
  v_mfma_f32_32x32x16_bf16 v[184:199], v[168:171], v[172:175], v[184:199]
  ds_read_b128 v[168:171], v14 offset:512
  ds_read_b128 v[172:175], v22 offset:512
  s_waitcnt lgkmcnt(10)
  v_mfma_f32_32x32x16_bf16 v[184:199], v[176:179], v[180:183], v[184:199]
  ds_read_b128 v[176:179], v15 offset:512
  ds_read_b128 v[180:183], v23 offset:512
  s_waitcnt lgkmcnt(10)
  v_mfma_f32_32x32x16_bf16 v[184:199], v[136:139], v[140:143], v[184:199]
  ds_read_b128 v[136:139], v8 offset:768
  ds_read_b128 v[140:143], v16 offset:768
  s_waitcnt lgkmcnt(10)
  v_mfma_f32_32x32x16_bf16 v[184:199], v[144:147], v[148:151], v[184:199]
  ds_read_b128 v[144:147], v9 offset:768
  ds_read_b128 v[148:151], v17 offset:768
  s_waitcnt lgkmcnt(10)
  v_mfma_f32_32x32x16_bf16 v[184:199], v[152:155], v[156:159], v[184:199]
  ds_read_b128 v[152:155], v10 offset:768
  ds_read_b128 v[156:159], v18 offset:768
  s_waitcnt lgkmcnt(10)
  v_mfma_f32_32x32x16_bf16 v[184:199], v[160:163], v[164:167], v[184:199]
  ds_read_b128 v[160:163], v11 offset:768
  ds_read_b128 v[164:167], v19 offset:768
  s_waitcnt lgkmcnt(10)
  v_mfma_f32_32x32x16_bf16 v[184:199], v[168:171], v[172:175], v[184:199]
  ds_read_b128 v[168:171], v12 offset:768
  ds_read_b128 v[172:175], v20 offset:768
  s_waitcnt lgkmcnt(10)
  v_mfma_f32_32x32x16_bf16 v[184:199], v[176:179], v[180:183], v[184:199]
  ds_read_b128 v[176:179], v13 offset:768
  ds_read_b128 v[180:183], v21 offset:768
  s_waitcnt lgkmcnt(10)
  v_mfma_f32_32x32x16_bf16 v[184:199], v[136:139], v[140:143], v[184:199]
  ds_read_b128 v[136:139], v14 offset:768
  ds_read_b128 v[140:143], v22 offset:768
  s_waitcnt lgkmcnt(10)
  v_mfma_f32_32x32x16_bf16 v[184:199], v[144:147], v[148:151], v[184:199]
  ds_read_b128 v[144:147], v15 offset:768
  ds_read_b128 v[148:151], v23 offset:768
  s_waitcnt lgkmcnt(10)
  v_mfma_f32_32x32x16_bf16 v[184:199], v[152:155], v[156:159], v[184:199]
  s_waitcnt lgkmcnt(8)
  v_mfma_f32_32x32x16_bf16 v[184:199], v[160:163], v[164:167], v[184:199]
  s_waitcnt lgkmcnt(6)
  v_mfma_f32_32x32x16_bf16 v[184:199], v[168:171], v[172:175], v[184:199]
  s_waitcnt lgkmcnt(4)
  v_mfma_f32_32x32x16_bf16 v[184:199], v[176:179], v[180:183], v[184:199]
  s_waitcnt lgkmcnt(2)
  v_mfma_f32_32x32x16_bf16 v[184:199], v[136:139], v[140:143], v[184:199]
  s_waitcnt lgkmcnt(0)
  v_mfma_f32_32x32x16_bf16 v[184:199], v[144:147], v[148:151], v[184:199]
  s_nop 11
  v_max3_f32 v4, v184, v185, v186
  v_max3_f32 v5, v187, v188, v189
  v_max3_f32 v6, v190, v191, v192
  v_max3_f32 v7, v193, v194, v195
  v_max3_f32 v4, v4, v196, v197
  v_max3_f32 v5, v5, v198, v199
  v_max3_f32 v4, v4, v6, v7
  v_max_f32 v4, v4, v5
  v_mov_b32 v5, v4
  s_nop 1
  v_permlane32_swap_b32 v4, v5
  v_max_f32 v4, v4, v5
  ds_write_b32 v208, v4
  s_waitcnt lgkmcnt(0)
  s_barrier
  ds_read_b32 v40, v209
  ds_read_b32 v41, v209 offset:32768
  v_add_u32 v44, 0x10000, v209
  ds_read_b32 v42, v44
  ds_read_b32 v43, v44 offset:32768
  s_waitcnt lgkmcnt(0)
  v_max3_f32 v4, v40, v41, v42
  v_max_f32 v4, v4, v43
  v_mov_b32 v5, v4
  v_pk_add_f32 v[184:185], v[184:185], v[4:5] neg_lo:[0,1] neg_hi:[0,1]
  v_pk_add_f32 v[186:187], v[186:187], v[4:5] neg_lo:[0,1] neg_hi:[0,1]
  v_pk_add_f32 v[188:189], v[188:189], v[4:5] neg_lo:[0,1] neg_hi:[0,1]
  v_pk_add_f32 v[190:191], v[190:191], v[4:5] neg_lo:[0,1] neg_hi:[0,1]
  v_pk_add_f32 v[192:193], v[192:193], v[4:5] neg_lo:[0,1] neg_hi:[0,1]
  v_pk_add_f32 v[194:195], v[194:195], v[4:5] neg_lo:[0,1] neg_hi:[0,1]
  v_pk_add_f32 v[196:197], v[196:197], v[4:5] neg_lo:[0,1] neg_hi:[0,1]
  v_pk_add_f32 v[198:199], v[198:199], v[4:5] neg_lo:[0,1] neg_hi:[0,1]
  v_exp_f32 v184, v184
  v_exp_f32 v185, v185
  v_exp_f32 v186, v186
  v_exp_f32 v187, v187
  v_exp_f32 v188, v188
  v_exp_f32 v189, v189
  v_exp_f32 v190, v190
  v_exp_f32 v191, v191
  v_cvt_pk_bf16_f32 v40, v184, v185
  v_cvt_pk_bf16_f32 v41, v186, v187
  ds_write_b64 v210, v[40:41] offset:0
  v_exp_f32 v192, v192
  v_exp_f32 v193, v193
  v_exp_f32 v194, v194
  v_exp_f32 v195, v195
  v_cvt_pk_bf16_f32 v42, v188, v189
  v_cvt_pk_bf16_f32 v43, v190, v191
  ds_write_b64 v210, v[42:43] offset:16
  v_exp_f32 v196, v196
  v_exp_f32 v197, v197
  v_exp_f32 v198, v198
  v_exp_f32 v199, v199
  v_cvt_pk_bf16_f32 v44, v192, v193
  v_cvt_pk_bf16_f32 v45, v194, v195
  ds_write_b64 v210, v[44:45] offset:32
  v_cvt_pk_bf16_f32 v46, v196, v197
  v_cvt_pk_bf16_f32 v47, v198, v199
  ds_write_b64 v210, v[46:47] offset:48
  s_waitcnt lgkmcnt(0)
  s_barrier
  s_branch L_join2_17
L_pvonly_16:
  s_mov_b32 s64, 0
  s_cmp_lt_u32 s61, 112
  s_cselect_b32 s54, 1, 0
  s_cmp_ge_u32 s44, 4
  s_cselect_b32 s64, s54, 0
  s_cmp_eq_u32 s64, 1
  s_cbranch_scc0 L_nfl_18
  v_lshrrev_b32 v5, 3, v1
  v_and_b32 v6, 7, v1
  v_lshlrev_b32 v6, 4, v6
  s_movk_i32 s54, 3584
  v_mul_lo_u32 v5, v5, s54
  v_add_u32 v5, v5, v6
  s_sub_u32 s58, s44, 4
  s_lshl_b32 s54, s49, 7
  s_lshl_b32 s55, s58, 5
  s_add_u32 s54, s54, s55
  s_mul_i32 s54, s54, 3584
  s_lshl_b32 s55, s48, 7
  s_add_u32 s54, s54, s55
  s_mov_b32 s36, s18
  s_mov_b32 s37, s19
  s_mov_b32 s38, 1835008
  s_mov_b32 s39, 0x20000
  s_add_u32 s57, s54, 0
  buffer_load_dwordx4 v[8:11], v5, s[36:39], s57 offen nt
  s_add_u32 s57, s54, 28672
  buffer_load_dwordx4 v[12:15], v5, s[36:39], s57 offen nt
  s_add_u32 s57, s54, 57344
  buffer_load_dwordx4 v[16:19], v5, s[36:39], s57 offen nt
  s_add_u32 s57, s54, 86016
  buffer_load_dwordx4 v[20:23], v5, s[36:39], s57 offen nt
  s_mov_b32 s36, s20
  s_mov_b32 s37, s21
  s_mov_b32 s38, 1835008
  s_mov_b32 s39, 0x20000
  s_add_u32 s57, s54, 0
  buffer_load_dwordx4 v[168:171], v5, s[36:39], s57 offen nt
  s_add_u32 s57, s54, 28672
  buffer_load_dwordx4 v[172:175], v5, s[36:39], s57 offen nt
  s_add_u32 s57, s54, 57344
  buffer_load_dwordx4 v[176:179], v5, s[36:39], s57 offen nt
  s_add_u32 s57, s54, 86016
  buffer_load_dwordx4 v[180:183], v5, s[36:39], s57 offen nt
L_nfl_18:
  s_barrier
  s_cmp_eq_u32 s44, 4
  s_cbranch_scc0 L_skip_19
  v_mov_b32 v41, 0
  v_mov_b32 v42, 114304
  ds_write_b32 v42, v41
  s_waitcnt lgkmcnt(0)
L_skip_19:
  s_barrier
L_join2_17:
  s_cmp_lt_u32 s44, 4
  s_cbranch_scc0 L_skip_20
  v_add_f32 v40, v184, v185
  v_add_f32 v41, v186, v187
  v_add_f32 v42, v188, v189
  v_add_f32 v43, v190, v191
  v_add_f32 v44, v192, v193
  v_add_f32 v45, v194, v195
  v_add_f32 v46, v196, v197
  v_add_f32 v47, v198, v199
  v_add_f32 v40, v40, v44
  v_add_f32 v41, v41, v45
  v_add_f32 v42, v42, v46
  v_add_f32 v43, v43, v47
  v_add_f32 v40, v40, v41
  v_add_f32 v42, v42, v43
  v_add_f32 v40, v40, v42
  v_mov_b32 v41, v40
  s_nop 1
  v_permlane32_swap_b32 v40, v41
  v_add_f32 v40, v40, v41
  ds_write_b32 v208, v40 offset:4096
  v_mov_b32 v41, 1
  v_mov_b32 v42, 114304
  s_waitcnt lgkmcnt(0)
  s_mov_b64 s[62:63], exec
  s_mov_b64 exec, 1
  ds_add_rtn_u32 v43, v42, v41
  s_waitcnt lgkmcnt(0)
  s_mov_b64 exec, s[62:63]
  v_readfirstlane_b32 s54, v43
  s_nop 0
  s_cmp_eq_u32 s54, 3
  s_cbranch_scc0 L_skip_20
  ds_read_b32 v40, v209 offset:4096
  ds_read_b32 v41, v209 offset:36864
  v_add_u32 v44, 0x10000, v209
  ds_read_b32 v42, v44 offset:4096
  ds_read_b32 v43, v44 offset:36864
  v_mov_b32 v6, s51
  v_mov_b32 v7, s51
  s_waitcnt lgkmcnt(0)
  v_add_f32 v5, v40, v41
  v_add_f32 v42, v42, v43
  v_add_f32 v5, v5, v42
  v_cmp_gt_u32 vcc, 32, v1
  s_nop 0
  s_and_saveexec_b64 s[62:63], vcc
  buffer_store_dwordx4 v[4:7], v249, s[32:35], s75 offen sc1
  s_mov_b64 exec, s[62:63]
  s_nop 1
L_skip_20:
  ds_read_b128 v[136:139], v211 offset:0
  ds_read_b128 v[140:143], v211 offset:32768
  ds_read_b128 v[144:147], v212 offset:0
  ds_read_b128 v[148:151], v212 offset:32768
  ds_read_b128 v[152:155], v211 offset:1280
  ds_read_b128 v[156:159], v211 offset:34048
  ds_read_b128 v[160:163], v212 offset:1280
  ds_read_b128 v[164:167], v212 offset:34048
  s_waitcnt lgkmcnt(7)
  v_mfma_f32_16x16x32_bf16 v[40:43], v[72:75], v[136:139], 0
  v_mfma_f32_16x16x32_bf16 v[44:47], v[88:91], v[136:139], 0
  v_mfma_f32_16x16x32_bf16 v[48:51], v[104:107], v[136:139], 0
  v_mfma_f32_16x16x32_bf16 v[52:55], v[120:123], v[136:139], 0
  s_waitcnt lgkmcnt(6)
  v_mfma_f32_16x16x32_bf16 v[40:43], v[76:79], v[140:143], v[40:43]
  v_mfma_f32_16x16x32_bf16 v[44:47], v[92:95], v[140:143], v[44:47]
  v_mfma_f32_16x16x32_bf16 v[48:51], v[108:111], v[140:143], v[48:51]
  v_mfma_f32_16x16x32_bf16 v[52:55], v[124:127], v[140:143], v[52:55]
  s_waitcnt lgkmcnt(5)
  v_mfma_f32_16x16x32_bf16 v[40:43], v[80:83], v[144:147], v[40:43]
  v_mfma_f32_16x16x32_bf16 v[44:47], v[96:99], v[144:147], v[44:47]
  v_mfma_f32_16x16x32_bf16 v[48:51], v[112:115], v[144:147], v[48:51]
  v_mfma_f32_16x16x32_bf16 v[52:55], v[128:131], v[144:147], v[52:55]
  s_waitcnt lgkmcnt(4)
  v_mfma_f32_16x16x32_bf16 v[40:43], v[84:87], v[148:151], v[40:43]
  v_mfma_f32_16x16x32_bf16 v[44:47], v[100:103], v[148:151], v[44:47]
  v_mfma_f32_16x16x32_bf16 v[48:51], v[116:119], v[148:151], v[48:51]
  v_mfma_f32_16x16x32_bf16 v[52:55], v[132:135], v[148:151], v[52:55]
  s_waitcnt lgkmcnt(0)
  v_mfma_f32_16x16x32_bf16 v[56:59], v[72:75], v[152:155], 0
  v_mfma_f32_16x16x32_bf16 v[60:63], v[88:91], v[152:155], 0
  v_mfma_f32_16x16x32_bf16 v[64:67], v[104:107], v[152:155], 0
  v_mfma_f32_16x16x32_bf16 v[68:71], v[120:123], v[152:155], 0
  v_cvt_pk_bf16_f32 v24, v40, v41
  v_cvt_pk_bf16_f32 v25, v42, v43
  ds_write_b64 v213, v[24:25] offset:0
  v_mfma_f32_16x16x32_bf16 v[56:59], v[76:79], v[156:159], v[56:59]
  v_cvt_pk_bf16_f32 v26, v44, v45
  v_cvt_pk_bf16_f32 v27, v46, v47
  ds_write_b64 v213, v[26:27] offset:32
  v_mfma_f32_16x16x32_bf16 v[60:63], v[92:95], v[156:159], v[60:63]
  v_cvt_pk_bf16_f32 v28, v48, v49
  v_cvt_pk_bf16_f32 v29, v50, v51
  ds_write_b64 v213, v[28:29] offset:64
  v_mfma_f32_16x16x32_bf16 v[64:67], v[108:111], v[156:159], v[64:67]
  v_cvt_pk_bf16_f32 v30, v52, v53
  v_cvt_pk_bf16_f32 v31, v54, v55
  ds_write_b64 v213, v[30:31] offset:96
  v_mfma_f32_16x16x32_bf16 v[68:71], v[124:127], v[156:159], v[68:71]
  v_mfma_f32_16x16x32_bf16 v[56:59], v[80:83], v[160:163], v[56:59]
  s_waitcnt lgkmcnt(0)
  ds_read_b128 v[224:227], v214
  ds_read_b128 v[228:231], v214 offset:1152
  v_mfma_f32_16x16x32_bf16 v[60:63], v[96:99], v[160:163], v[60:63]
  v_mfma_f32_16x16x32_bf16 v[64:67], v[112:115], v[160:163], v[64:67]
  v_mfma_f32_16x16x32_bf16 v[68:71], v[128:131], v[160:163], v[68:71]
  s_waitcnt lgkmcnt(1)
  v_and_or_b32 v224, v224, s79, v240
  v_and_or_b32 v225, v225, s79, v241
  v_and_or_b32 v226, v226, s79, v242
  v_and_or_b32 v227, v227, s79, v243
  buffer_store_dwordx4 v[224:227], v215, s[32:35], s71 offen sc1
  v_mfma_f32_16x16x32_bf16 v[56:59], v[84:87], v[164:167], v[56:59]
  v_mfma_f32_16x16x32_bf16 v[60:63], v[100:103], v[164:167], v[60:63]
  s_waitcnt lgkmcnt(0)
  v_and_or_b32 v228, v228, s79, v240
  v_and_or_b32 v229, v229, s79, v241
  v_and_or_b32 v230, v230, s79, v242
  v_and_or_b32 v231, v231, s79, v243
  buffer_store_dwordx4 v[228:231], v215, s[32:35], s72 offen sc1
  v_mfma_f32_16x16x32_bf16 v[64:67], v[116:119], v[164:167], v[64:67]
  v_mfma_f32_16x16x32_bf16 v[68:71], v[132:135], v[164:167], v[68:71]
  v_cvt_pk_bf16_f32 v32, v56, v57
  v_cvt_pk_bf16_f32 v33, v58, v59
  ds_write_b64 v213, v[32:33] offset:2304
  v_cvt_pk_bf16_f32 v34, v60, v61
  v_cvt_pk_bf16_f32 v35, v62, v63
  ds_write_b64 v213, v[34:35] offset:2336
  s_nop 0
  v_cvt_pk_bf16_f32 v36, v64, v65
  v_cvt_pk_bf16_f32 v37, v66, v67
  ds_write_b64 v213, v[36:37] offset:2368
  v_cvt_pk_bf16_f32 v38, v68, v69
  v_cvt_pk_bf16_f32 v39, v70, v71
  ds_write_b64 v213, v[38:39] offset:2400
  s_waitcnt lgkmcnt(0)
  ds_read_b128 v[232:235], v214 offset:2304
  ds_read_b128 v[236:239], v214 offset:3456
  s_waitcnt lgkmcnt(1)
  v_and_or_b32 v232, v232, s79, v240
  v_and_or_b32 v233, v233, s79, v241
  v_and_or_b32 v234, v234, s79, v242
  v_and_or_b32 v235, v235, s79, v243
  buffer_store_dwordx4 v[232:235], v215, s[32:35], s73 offen sc1
  s_waitcnt lgkmcnt(0)
  v_and_or_b32 v236, v236, s79, v240
  v_and_or_b32 v237, v237, s79, v241
  v_and_or_b32 v238, v238, s79, v242
  v_and_or_b32 v239, v239, s79, v243
  buffer_store_dwordx4 v[236:239], v215, s[32:35], s74 offen sc1
  s_cmp_lt_u32 s61, 112
  s_cbranch_scc0 L_fin
  s_cmp_ge_u32 s44, 4
  s_cbranch_scc0 L_skip_22
  v_lshrrev_b32 v5, 3, v1
  v_and_b32 v6, 7, v1
  v_and_b32 v7, 2, v5
  v_xor_b32 v6, v6, v7
  v_lshlrev_b32 v6, 4, v6
  v_lshl_add_u32 v5, v5, 7, v6
  s_sub_u32 s58, s44, 4
  s_lshl_b32 s56, s58, 12
  v_add_u32 v5, s56, v5
  v_add_u32 v5, 131072, v5
  v_xor_b32 v6, 64, v5
  s_waitcnt vmcnt(4)
  ds_write_b128 v5, v[8:11] offset:0
  ds_write_b128 v5, v[168:171] offset:16384
  ds_write_b128 v6, v[12:15] offset:1024
  ds_write_b128 v6, v[172:175] offset:17408
  ds_write_b128 v5, v[16:19] offset:2048
  ds_write_b128 v5, v[176:179] offset:18432
  ds_write_b128 v6, v[20:23] offset:3072
  ds_write_b128 v6, v[180:183] offset:19456
  s_lshl_b32 s55, s58, 2
  s_mov_b32 s40, s22
  s_mov_b32 s41, s23
  s_mov_b32 s42, 1835008
  s_mov_b32 s43, 0x20000
  s_lshl_b32 s54, s61, 4
  s_add_u32 s54, s54, s55
  s_lshl_b32 s54, s54, 10
  s_add_u32 s59, s55, 0
  s_and_b32 s59, s59, 7
  s_lshl_b32 s59, s59, 1
  v_xor_b32 v7, s59, v1
  v_lshlrev_b32 v7, 4, v7
  s_add_u32 s57, s54, 0
  s_add_u32 m0, s56, 16384
  s_nop 0
  buffer_load_dwordx4 v7, s[40:43], s57 offen nt lds
  s_add_u32 s59, s55, 1
  s_and_b32 s59, s59, 7
  s_lshl_b32 s59, s59, 1
  v_xor_b32 v7, s59, v1
  v_lshlrev_b32 v7, 4, v7
  s_add_u32 s57, s54, 1024
  s_add_u32 m0, s56, 17408
  s_nop 0
  buffer_load_dwordx4 v7, s[40:43], s57 offen nt lds
  s_add_u32 s59, s55, 2
  s_and_b32 s59, s59, 7
  s_lshl_b32 s59, s59, 1
  v_xor_b32 v7, s59, v1
  v_lshlrev_b32 v7, 4, v7
  s_add_u32 s57, s54, 2048
  s_add_u32 m0, s56, 18432
  s_nop 0
  buffer_load_dwordx4 v7, s[40:43], s57 offen nt lds
  s_add_u32 s59, s55, 3
  s_and_b32 s59, s59, 7
  s_lshl_b32 s59, s59, 1
  v_xor_b32 v7, s59, v1
  v_lshlrev_b32 v7, 4, v7
  s_add_u32 s57, s54, 3072
  s_add_u32 m0, s56, 19456
  s_nop 0
  buffer_load_dwordx4 v7, s[40:43], s57 offen nt lds
  s_waitcnt lgkmcnt(0)
L_skip_22:
  s_mov_b32 s64, 0x0c0c0400
  s_mov_b32 s65, 0x04000c0c
  v_lshrrev_b32 v36, 2, v2
  v_and_b32 v37, 3, v2
  v_and_b32 v38, 2, v36
  v_and_b32 v39, 1, v3
  v_lshl_add_u32 v38, v39, 2, v38
  v_lshrrev_b32 v39, 1, v37
  s_and_b32 s54, s44, 3
  s_lshl_b32 s54, s54, 1
  v_add_u32 v39, s54, v39
  v_xor_b32 v39, v39, v38
  v_lshlrev_b32 v39, 4, v39
  v_and_b32 v37, 1, v37
  v_lshl_add_u32 v39, v37, 3, v39
  v_lshl_add_u32 v36, v3, 3, v36
  v_lshl_add_u32 v4, v36, 7, v39
  s_lshr_b32 s54, s44, 2
  s_lshl_b32 s54, s54, 14
  s_add_u32 s54, s54, 131072
  v_add_u32 v4, s54, v4
  s_lshl_b32 s54, s61, 10
  s_lshr_b32 s55, s44, 2
  s_lshl_b32 s55, s55, 9
  s_add_u32 s54, s54, s55
  s_and_b32 s55, s44, 3
  s_lshl_b32 s55, s55, 6
  s_add_u32 s54, s54, s55
  s_add_u32 s68, s54, 1441792
  v_lshlrev_b32 v6, 8, v2
  v_lshl_add_u32 v6, v3, 4, v6
  s_barrier
  ds_read_b64_tr_b16 v[40:41], v4 offset:0
  ds_read_b64_tr_b16 v[42:43], v4 offset:512
  ds_read_b64_tr_b16 v[44:45], v4 offset:4096
  ds_read_b64_tr_b16 v[46:47], v4 offset:4608
  ds_read_b64_tr_b16 v[48:49], v4 offset:8192
  ds_read_b64_tr_b16 v[50:51], v4 offset:8704
  ds_read_b64_tr_b16 v[52:53], v4 offset:12288
  ds_read_b64_tr_b16 v[54:55], v4 offset:12800
  s_waitcnt lgkmcnt(6)
  v_mfma_f32_16x16x32_bf16 v[72:75], v[40:43], v[200:203], 0
  s_waitcnt lgkmcnt(4)
  v_mfma_f32_16x16x32_bf16 v[72:75], v[44:47], v[204:207], v[72:75]
  s_waitcnt lgkmcnt(2)
  v_mfma_f32_16x16x32_bf16 v[72:75], v[48:51], v[216:219], v[72:75]
  s_waitcnt lgkmcnt(0)
  v_mfma_f32_16x16x32_bf16 v[72:75], v[52:55], v[220:223], v[72:75]
  v_cmp_gt_u32 vcc, 2, v2
  s_nop 6
  v_bfi_b32 v72, v248, s51, v72
  v_bfi_b32 v73, v248, s76, v73
  v_bfi_b32 v74, v248, s77, v74
  v_bfi_b32 v75, v248, s78, v75
  s_and_saveexec_b64 s[62:63], vcc
  buffer_store_dwordx4 v[72:75], v6, s[32:35], s68 offen sc1
  s_mov_b64 exec, s[62:63]
  v_lshlrev_b32 v8, 10, v3
  v_bfe_u32 v7, v1, 3, 1
  v_lshl_add_u32 v8, v7, 9, v8
  v_bfe_u32 v7, v1, 2, 1
  v_lshl_add_u32 v8, v7, 8, v8
  v_and_b32 v7, 3, v1
  v_lshl_add_u32 v8, v7, 4, v8
  s_lshl_b32 s54, s48, 12
  s_lshl_b32 s55, s49, 6
  s_add_u32 s54, s54, s55
  s_add_u32 s69, s54, 1441792
  v_lshlrev_b32 v9, 3, v1
  s_lshl_b32 s54, s44, 6
  v_add_u32 v9, s54, v9
  v_add_u32 v9, 114688, v9
  v_and_b32 v10, 1, v1
  v_lshlrev_b32 v10, 5, v10
  v_lshl_add_u32 v10, v3, 3, v10
  v_add_u32 v10, s54, v10
  v_add_u32 v10, 114688, v10
  v_lshrrev_b32 v4, 2, v1
  v_and_b32 v5, 7, v4
  v_lshlrev_b32 v5, 1, v5
  v_and_b32 v44, 3, v2
  v_lshrrev_b32 v45, 1, v44
  s_lshl_b32 s54, s44, 3
  v_add_u32 v45, s54, v45
  v_xor_b32 v45, v45, v5
  v_lshlrev_b32 v45, 4, v45
  v_and_b32 v44, 1, v44
  v_lshl_add_u32 v45, v44, 3, v45
  v_lshl_add_u32 v45, v4, 10, v45
  v_add_u32 v45, 16384, v45
  s_lshl_b32 s54, s61, 12
  s_lshl_b32 s55, s44, 8
  s_add_u32 s54, s54, s55
  s_add_u32 s70, s54, 917504
  v_lshlrev_b32 v11, 11, v2
  v_lshl_add_u32 v11, v3, 4, v11
  s_waitcnt vmcnt(0)
  s_barrier
  v_xor_b32 v46, 0, v45
  ds_read_b64_tr_b16 v[48:49], v46
  v_xor_b32 v46, 32, v45
  ds_read_b64_tr_b16 v[50:51], v46
  v_xor_b32 v46, 64, v45
  ds_read_b64_tr_b16 v[52:53], v46
  v_xor_b32 v46, 96, v45
  ds_read_b64_tr_b16 v[54:55], v46
  s_mov_b32 s60, 20000
  s_mov_b64 s[62:63], exec
L_hg_23:
  s_sleep 2
  buffer_load_dwordx4 v[40:43], v8, s[32:35], s69 offen sc1
  s_waitcnt vmcnt(0)
  v_perm_b32 v252, v41, v40, s64
  v_perm_b32 v253, v43, v42, s65
  v_or_b32 v252, v252, v253
  v_xor_b32 v72, s51, v252
  v_cmp_ne_u32 vcc, 0, v72
  s_nop 0
  s_and_b64 vcc, vcc, exec
  s_cbranch_vccz L_done_24
  s_sub_u32 s60, s60, 1
  s_cbranch_scc1 L_done_24
  s_mov_b64 exec, vcc
  s_branch L_hg_23
L_done_24:
  s_mov_b64 exec, s[62:63]
  v_mov_b32 v44, v40
  v_mov_b32 v45, v41
  v_mov_b32 v46, v42
  v_mov_b32 v47, v43
  v_permlane16_swap_b32 v40, v44
  v_permlane16_swap_b32 v41, v45
  v_permlane16_swap_b32 v42, v46
  v_permlane16_swap_b32 v43, v47
  v_add_f32 v40, v40, v44
  v_mov_b32 v44, v40
  v_add_f32 v41, v41, v45
  v_mov_b32 v45, v41
  v_add_f32 v42, v42, v46
  v_mov_b32 v46, v42
  v_add_f32 v43, v43, v47
  v_mov_b32 v47, v43
  v_permlane32_swap_b32 v40, v44
  v_permlane32_swap_b32 v41, v45
  v_permlane32_swap_b32 v42, v46
  v_permlane32_swap_b32 v43, v47
  v_add_f32 v40, v40, v44
  v_add_f32 v41, v41, v45
  v_add_f32 v42, v42, v46
  v_add_f32 v43, v43, v47
  v_mov_b32_dpp v44, v40 row_ror:8 row_mask:0xf bank_mask:0xf
  v_mov_b32_dpp v45, v41 row_ror:8 row_mask:0xf bank_mask:0xf
  v_mov_b32_dpp v46, v42 row_ror:8 row_mask:0xf bank_mask:0xf
  v_mov_b32_dpp v47, v43 row_ror:8 row_mask:0xf bank_mask:0xf
  v_max_f32 v40, 0, v40
  v_mul_f32 v40, v40, v44
  v_max_f32 v41, 0, v41
  v_mul_f32 v41, v41, v45
  v_max_f32 v42, 0, v42
  v_mul_f32 v42, v42, v46
  v_max_f32 v43, 0, v43
  v_mul_f32 v43, v43, v47
  v_cmp_gt_u32 vcc, 8, v1
  v_cvt_pk_bf16_f32 v40, v40, v41
  v_cvt_pk_bf16_f32 v41, v42, v43
  s_and_saveexec_b64 s[62:63], vcc
  ds_write_b64 v9, v[40:41]
  s_mov_b64 exec, s[62:63]
  s_waitcnt lgkmcnt(0)
  ds_read_b64 v[56:57], v10
  s_waitcnt lgkmcnt(0)
  v_mfma_f32_16x16x16_bf16 v[112:115], v[48:49], v[56:57], 0
  v_mfma_f32_16x16x16_bf16 v[116:119], v[50:51], v[56:57], 0
  v_mfma_f32_16x16x16_bf16 v[120:123], v[52:53], v[56:57], 0
  v_mfma_f32_16x16x16_bf16 v[124:127], v[54:55], v[56:57], 0
  v_cmp_gt_u32 vcc, 2, v2
  s_nop 3
  v_bfi_b32 v112, v248, s51, v112
  v_bfi_b32 v113, v248, s76, v113
  v_bfi_b32 v114, v248, s77, v114
  v_bfi_b32 v115, v248, s78, v115
  v_bfi_b32 v116, v248, s51, v116
  v_bfi_b32 v117, v248, s76, v117
  v_bfi_b32 v118, v248, s77, v118
  v_bfi_b32 v119, v248, s78, v119
  v_bfi_b32 v120, v248, s51, v120
  v_bfi_b32 v121, v248, s76, v121
  v_bfi_b32 v122, v248, s77, v122
  v_bfi_b32 v123, v248, s78, v123
  v_bfi_b32 v124, v248, s51, v124
  v_bfi_b32 v125, v248, s76, v125
  v_bfi_b32 v126, v248, s77, v126
  v_bfi_b32 v127, v248, s78, v127
  s_and_saveexec_b64 s[62:63], vcc
  buffer_store_dwordx4 v[112:115], v11, s[32:35], s70 offen offset:0 sc1
  buffer_store_dwordx4 v[116:119], v11, s[32:35], s70 offen offset:64 sc1
  buffer_store_dwordx4 v[120:123], v11, s[32:35], s70 offen offset:128 sc1
  buffer_store_dwordx4 v[124:127], v11, s[32:35], s70 offen offset:192 sc1
  s_mov_b64 exec, s[62:63]
  s_branch L_fin
L_tail:
  s_mov_b32 s64, 0x0c0c0400
  s_mov_b32 s65, 0x04000c0c
  s_lshr_b32 s54, s44, 2
  s_and_b32 s55, s44, 3
  s_lshl_b32 s56, s48, 1
  s_add_u32 s56, s56, s54
  s_lshl_b32 s56, s56, 10
  s_add_u32 s66, s56, 393216
  s_lshl_b32 s57, s61, 15
  s_lshl_b32 s58, s54, 14
  s_add_u32 s57, s57, s58
  s_lshl_b32 s58, s55, 12
  s_add_u32 s57, s57, s58
  s_add_u32 s67, s57, 2097152
  v_lshlrev_b32 v36, 4, v1
  s_lshl_b32 s58, s55, 4
  v_add_u32 v37, s58, v3
  v_lshlrev_b32 v37, 2, v37
  s_lshl_b32 s58, s55, 1
  s_add_u32 s58, s58, s54
  s_mul_i32 s58, s58, 272
  s_add_u32 s58, s58, 144384
  v_lshlrev_b32 v38, 4, v2
  v_and_b32 v39, 1, v3
  v_lshl_add_u32 v38, v39, 2, v38
  v_lshrrev_b32 v39, 1, v3
  v_lshl_add_u32 v38, v39, 3, v38
  v_add_u32 v38, s58, v38
  v_and_b32 v39, 7, v2
  v_mul_u32_u24 v39, 272, v39
  v_lshl_add_u32 v39, v3, 4, v39
  v_add_u32 v39, 144384, v39
  v_mul_u32_u24 v68, 272, v2
  v_lshl_add_u32 v68, v3, 3, v68
  s_lshl_b32 s56, s44, 5
  v_add_u32 v68, s56, v68
  v_add_u32 v68, 155648, v68
  v_and_b32 v69, 1, v1
  v_mul_u32_u24 v69, 272, v69
  v_lshl_add_u32 v69, v3, 4, v69
  v_add_u32 v69, 155648, v69
  s_lshl_b32 s56, s61, 12
  s_lshl_b32 s57, s44, 10
  s_add_u32 s56, s56, s57
  s_add_u32 s70, s56, 1572864
  v_lshlrev_b32 v71, 11, v2
  v_lshl_add_u32 v71, v3, 4, v71
  v_lshlrev_b32 v90, 4, v1
  v_add_u32 v90, s57, v90
  s_add_u32 s58, s49, 0
  s_and_b32 s58, s58, 3
  s_lshl_b32 s58, s58, 9
  s_lshl_b32 s59, s44, 6
  s_add_u32 s72, s58, s59
  s_add_u32 s58, s49, 1
  s_and_b32 s58, s58, 3
  s_lshl_b32 s58, s58, 9
  s_lshl_b32 s59, s44, 6
  s_add_u32 s73, s58, s59
  s_add_u32 s58, s49, 2
  s_and_b32 s58, s58, 3
  s_lshl_b32 s58, s58, 9
  s_lshl_b32 s59, s44, 6
  s_add_u32 s74, s58, s59
  s_add_u32 s58, s49, 3
  s_and_b32 s58, s58, 3
  s_lshl_b32 s58, s58, 9
  s_lshl_b32 s59, s44, 6
  s_add_u32 s75, s58, s59
  s_lshl_b32 s58, s54, 8
  v_lshlrev_b32 v70, 2, v1
  v_add_u32 v70, s58, v70
  v_add_u32 v70, 152576, v70
  v_add_u32 v37, s58, v37
  v_add_u32 v37, 152576, v37
  v_add_u32 v89, 0x10000, v34
  s_waitcnt vmcnt(0)
  s_barrier
  ds_read_b64_tr_b16 v[96:97], v89 offset:32768
  ds_read_b64_tr_b16 v[98:99], v89 offset:33792
  ds_read_b64_tr_b16 v[100:101], v89 offset:40960
  ds_read_b64_tr_b16 v[102:103], v89 offset:41984
  ds_read_b64_tr_b16 v[104:105], v89 offset:49152
  ds_read_b64_tr_b16 v[106:107], v89 offset:50176
  ds_read_b64_tr_b16 v[108:109], v89 offset:57344
  ds_read_b64_tr_b16 v[110:111], v89 offset:58368
  ds_read_b64_tr_b16 v[112:113], v89 offset:0
  ds_read_b64_tr_b16 v[114:115], v89 offset:1024
  ds_read_b64_tr_b16 v[116:117], v89 offset:8192
  ds_read_b64_tr_b16 v[118:119], v89 offset:9216
  ds_read_b64_tr_b16 v[120:121], v89 offset:16384
  ds_read_b64_tr_b16 v[122:123], v89 offset:17408
  ds_read_b64_tr_b16 v[124:125], v89 offset:24576
  ds_read_b64_tr_b16 v[126:127], v89 offset:25600
  ds_read_b64_tr_b16 v[128:129], v34 offset:32768
  ds_read_b64_tr_b16 v[130:131], v34 offset:33792
  ds_read_b64_tr_b16 v[132:133], v34 offset:40960
  ds_read_b64_tr_b16 v[134:135], v34 offset:41984
  ds_read_b64_tr_b16 v[136:137], v34 offset:49152
  ds_read_b64_tr_b16 v[138:139], v34 offset:50176
  ds_read_b64_tr_b16 v[140:141], v34 offset:57344
  ds_read_b64_tr_b16 v[142:143], v34 offset:58368
  ds_read_b64_tr_b16 v[144:145], v34 offset:0
  ds_read_b64_tr_b16 v[146:147], v34 offset:1024
  ds_read_b64_tr_b16 v[148:149], v34 offset:8192
  ds_read_b64_tr_b16 v[150:151], v34 offset:9216
  ds_read_b64_tr_b16 v[152:153], v34 offset:16384
  ds_read_b64_tr_b16 v[154:155], v34 offset:17408
  ds_read_b64_tr_b16 v[156:157], v34 offset:24576
  ds_read_b64_tr_b16 v[158:159], v34 offset:25600
  s_cmp_eq_u32 s55, 0
  s_cbranch_scc0 L_nst_25
  s_mov_b32 s60, 20000
  s_mov_b64 s[62:63], exec
L_h3s_26:
  buffer_load_dwordx4 v[40:43], v36, s[32:35], s66 offen sc1
  s_waitcnt vmcnt(0)
  v_cmp_ne_u32 vcc, s51, v42
  s_nop 0
  s_and_b64 vcc, vcc, exec
  s_cbranch_vccz L_done_27
  s_sub_u32 s60, s60, 1
  s_cbranch_scc1 L_done_27
  s_mov_b64 exec, vcc
  s_sleep 2
  s_branch L_h3s_26
L_done_27:
  s_mov_b64 exec, s[62:63]
  v_mov_b32 v56, v40
  s_nop 1
  v_max_f32_dpp v56, v56, v56 row_ror:8 row_mask:0xf bank_mask:0xf
  s_nop 1
  v_max_f32_dpp v56, v56, v56 row_ror:4 row_mask:0xf bank_mask:0xf
  s_nop 1
  v_max_f32_dpp v56, v56, v56 row_ror:2 row_mask:0xf bank_mask:0xf
  s_nop 1
  v_max_f32_dpp v56, v56, v56 row_ror:1 row_mask:0xf bank_mask:0xf
  v_mov_b32 v58, v56
  s_nop 1
  v_permlane16_swap_b32 v56, v58
  v_max_f32 v56, v56, v58
  v_mov_b32 v58, v56
  s_nop 1
  v_permlane32_swap_b32 v56, v58
  v_max_f32 v56, v56, v58
  v_sub_f32 v40, v40, v56
  v_exp_f32 v40, v40
  s_nop 0
  v_mul_f32 v41, v40, v41
  s_nop 1
  v_add_f32_dpp v41, v41, v41 row_ror:8 row_mask:0xf bank_mask:0xf
  s_nop 1
  v_add_f32_dpp v41, v41, v41 row_ror:4 row_mask:0xf bank_mask:0xf
  s_nop 1
  v_add_f32_dpp v41, v41, v41 row_ror:2 row_mask:0xf bank_mask:0xf
  s_nop 1
  v_add_f32_dpp v41, v41, v41 row_ror:1 row_mask:0xf bank_mask:0xf
  v_mov_b32 v58, v41
  s_nop 1
  v_permlane16_swap_b32 v41, v58
  v_add_f32 v41, v41, v58
  v_mov_b32 v58, v41
  s_nop 1
  v_permlane32_swap_b32 v41, v58
  v_add_f32 v41, v41, v58
  v_rcp_f32 v41, v41
  s_nop 0
  v_mul_f32 v40, v40, v41
  ds_write_b32 v70, v40
  s_waitcnt lgkmcnt(0)
L_nst_25:
  s_barrier
  s_mov_b32 s60, 20000
  s_mov_b64 s[62:63], exec
L_h3o_28:
  buffer_load_dwordx4 v[40:43], v36, s[32:35], s67 offen offset:0 sc1
  buffer_load_dwordx4 v[44:47], v36, s[32:35], s67 offen offset:1024 sc1
  buffer_load_dwordx4 v[48:51], v36, s[32:35], s67 offen offset:2048 sc1
  buffer_load_dwordx4 v[52:55], v36, s[32:35], s67 offen offset:3072 sc1
  ds_read_b32 v64, v37 offset:0
  ds_read_b32 v65, v37 offset:16
  ds_read_b32 v66, v37 offset:32
  ds_read_b32 v67, v37 offset:48
  s_waitcnt vmcnt(0)
  v_xor_b32 v252, v40, v244
  v_xor_b32 v253, v41, v245
  v_or_b32 v72, v252, v253
  v_xor_b32 v252, v42, v246
  v_xor_b32 v253, v43, v247
  v_or3_b32 v72, v72, v252, v253
  v_xor_b32 v252, v44, v244
  v_xor_b32 v253, v45, v245
  v_or3_b32 v72, v72, v252, v253
  v_xor_b32 v252, v46, v246
  v_xor_b32 v253, v47, v247
  v_or3_b32 v72, v72, v252, v253
  v_xor_b32 v252, v48, v244
  v_xor_b32 v253, v49, v245
  v_or3_b32 v72, v72, v252, v253
  v_xor_b32 v252, v50, v246
  v_xor_b32 v253, v51, v247
  v_or3_b32 v72, v72, v252, v253
  v_xor_b32 v252, v52, v244
  v_xor_b32 v253, v53, v245
  v_or3_b32 v72, v72, v252, v253
  v_xor_b32 v252, v54, v246
  v_xor_b32 v253, v55, v247
  v_or3_b32 v72, v72, v252, v253
  v_and_b32 v72, 0x10001, v72
  s_nop 1
  v_or_b32_dpp v72, v72, v72 quad_perm:[1,0,3,2] row_mask:0xf bank_mask:0xf
  s_nop 1
  v_or_b32_dpp v72, v72, v72 quad_perm:[2,3,0,1] row_mask:0xf bank_mask:0xf
  v_cmp_ne_u32 vcc, 0, v72
  s_nop 0
  s_and_b64 vcc, vcc, exec
  s_cbranch_vccz L_done_29
  s_sub_u32 s60, s60, 1
  s_cbranch_scc1 L_done_29
  s_mov_b64 exec, vcc
  s_sleep 2
  s_branch L_h3o_28
L_done_29:
  s_mov_b64 exec, s[62:63]
  s_waitcnt lgkmcnt(0)
  v_lshlrev_b32 v72, 16, v40
  v_and_b32 v73, 0xffff0000, v40
  v_mul_f32 v56, v64, v72
  v_mul_f32 v57, v64, v73
  v_lshlrev_b32 v72, 16, v41
  v_and_b32 v73, 0xffff0000, v41
  v_mul_f32 v58, v64, v72
  v_mul_f32 v59, v64, v73
  v_lshlrev_b32 v72, 16, v42
  v_and_b32 v73, 0xffff0000, v42
  v_mul_f32 v60, v64, v72
  v_mul_f32 v61, v64, v73
  v_lshlrev_b32 v72, 16, v43
  v_and_b32 v73, 0xffff0000, v43
  v_mul_f32 v62, v64, v72
  v_mul_f32 v63, v64, v73
  v_lshlrev_b32 v72, 16, v44
  v_and_b32 v73, 0xffff0000, v44
  v_fmac_f32 v56, v65, v72
  v_fmac_f32 v57, v65, v73
  v_lshlrev_b32 v72, 16, v45
  v_and_b32 v73, 0xffff0000, v45
  v_fmac_f32 v58, v65, v72
  v_fmac_f32 v59, v65, v73
  v_lshlrev_b32 v72, 16, v46
  v_and_b32 v73, 0xffff0000, v46
  v_fmac_f32 v60, v65, v72
  v_fmac_f32 v61, v65, v73
  v_lshlrev_b32 v72, 16, v47
  v_and_b32 v73, 0xffff0000, v47
  v_fmac_f32 v62, v65, v72
  v_fmac_f32 v63, v65, v73
  v_lshlrev_b32 v72, 16, v48
  v_and_b32 v73, 0xffff0000, v48
  v_fmac_f32 v56, v66, v72
  v_fmac_f32 v57, v66, v73
  v_lshlrev_b32 v72, 16, v49
  v_and_b32 v73, 0xffff0000, v49
  v_fmac_f32 v58, v66, v72
  v_fmac_f32 v59, v66, v73
  v_lshlrev_b32 v72, 16, v50
  v_and_b32 v73, 0xffff0000, v50
  v_fmac_f32 v60, v66, v72
  v_fmac_f32 v61, v66, v73
  v_lshlrev_b32 v72, 16, v51
  v_and_b32 v73, 0xffff0000, v51
  v_fmac_f32 v62, v66, v72
  v_fmac_f32 v63, v66, v73
  v_lshlrev_b32 v72, 16, v52
  v_and_b32 v73, 0xffff0000, v52
  v_fmac_f32 v56, v67, v72
  v_fmac_f32 v57, v67, v73
  v_lshlrev_b32 v72, 16, v53
  v_and_b32 v73, 0xffff0000, v53
  v_fmac_f32 v58, v67, v72
  v_fmac_f32 v59, v67, v73
  v_lshlrev_b32 v72, 16, v54
  v_and_b32 v73, 0xffff0000, v54
  v_fmac_f32 v60, v67, v72
  v_fmac_f32 v61, v67, v73
  v_lshlrev_b32 v72, 16, v55
  v_and_b32 v73, 0xffff0000, v55
  v_fmac_f32 v62, v67, v72
  v_fmac_f32 v63, v67, v73
  v_permlane32_swap_b32 v56, v60
  v_permlane32_swap_b32 v57, v61
  v_permlane32_swap_b32 v58, v62
  v_permlane32_swap_b32 v59, v63
  v_add_f32 v56, v56, v60
  v_add_f32 v57, v57, v61
  v_add_f32 v58, v58, v62
  v_add_f32 v59, v59, v63
  s_nop 0
  v_permlane16_swap_b32 v56, v58
  v_permlane16_swap_b32 v57, v59
  v_add_f32 v56, v56, v58
  v_add_f32 v57, v57, v59
  v_cvt_pk_bf16_f32 v56, v56, v57
  ds_write_b32 v38, v56
  s_waitcnt lgkmcnt(0)
  s_barrier
  ds_read_b128 v[40:43], v39 offset:0
  ds_read_b128 v[44:47], v39 offset:64
  ds_read_b128 v[48:51], v39 offset:128
  ds_read_b128 v[52:55], v39 offset:192
  s_waitcnt lgkmcnt(3)
  v_mfma_f32_16x16x32_bf16 v[72:75], v[8:11], v[40:43], 0
  s_waitcnt lgkmcnt(2)
  v_mfma_f32_16x16x32_bf16 v[72:75], v[12:15], v[44:47], v[72:75]
  s_waitcnt lgkmcnt(1)
  v_mfma_f32_16x16x32_bf16 v[72:75], v[16:19], v[48:51], v[72:75]
  s_waitcnt lgkmcnt(0)
  v_mfma_f32_16x16x32_bf16 v[72:75], v[20:23], v[52:55], v[72:75]
  s_nop 7
  v_add_f32_dpp v72, v72, v72 row_ror:4 row_mask:0xf bank_mask:0xf
  v_add_f32_dpp v73, v73, v73 row_ror:4 row_mask:0xf bank_mask:0xf
  v_add_f32_dpp v74, v74, v74 row_ror:4 row_mask:0xf bank_mask:0xf
  v_add_f32_dpp v75, v75, v75 row_ror:4 row_mask:0xf bank_mask:0xf
  v_add_f32_dpp v72, v72, v72 row_ror:2 row_mask:0xf bank_mask:0xf
  v_add_f32_dpp v73, v73, v73 row_ror:2 row_mask:0xf bank_mask:0xf
  v_add_f32_dpp v74, v74, v74 row_ror:2 row_mask:0xf bank_mask:0xf
  v_add_f32_dpp v75, v75, v75 row_ror:2 row_mask:0xf bank_mask:0xf
  v_cmp_gt_u32 vcc, 2, v2
  v_cvt_pk_bf16_f32 v76, v72, v73
  v_cvt_pk_bf16_f32 v77, v74, v75
  s_and_saveexec_b64 s[62:63], vcc
  ds_write_b64 v68, v[76:77]
  s_mov_b64 exec, s[62:63]
  s_waitcnt lgkmcnt(0)
  s_barrier
  ds_read_b128 v[40:43], v69 offset:0
  ds_read_b128 v[44:47], v69 offset:64
  ds_read_b128 v[48:51], v69 offset:128
  ds_read_b128 v[52:55], v69 offset:192
  s_waitcnt lgkmcnt(3)
  v_mfma_f32_16x16x32_bf16 v[72:75], v[96:99], v[40:43], 0
  v_mfma_f32_16x16x32_bf16 v[76:79], v[112:115], v[40:43], 0
  v_mfma_f32_16x16x32_bf16 v[80:83], v[128:131], v[40:43], 0
  v_mfma_f32_16x16x32_bf16 v[84:87], v[144:147], v[40:43], 0
  s_waitcnt lgkmcnt(2)
  v_mfma_f32_16x16x32_bf16 v[72:75], v[100:103], v[44:47], v[72:75]
  v_mfma_f32_16x16x32_bf16 v[76:79], v[116:119], v[44:47], v[76:79]
  v_mfma_f32_16x16x32_bf16 v[80:83], v[132:135], v[44:47], v[80:83]
  v_mfma_f32_16x16x32_bf16 v[84:87], v[148:151], v[44:47], v[84:87]
  s_waitcnt lgkmcnt(1)
  v_mfma_f32_16x16x32_bf16 v[72:75], v[104:107], v[48:51], v[72:75]
  v_mfma_f32_16x16x32_bf16 v[76:79], v[120:123], v[48:51], v[76:79]
  v_mfma_f32_16x16x32_bf16 v[80:83], v[136:139], v[48:51], v[80:83]
  v_mfma_f32_16x16x32_bf16 v[84:87], v[152:155], v[48:51], v[84:87]
  s_waitcnt lgkmcnt(0)
  v_mfma_f32_16x16x32_bf16 v[72:75], v[108:111], v[52:55], v[72:75]
  v_mfma_f32_16x16x32_bf16 v[76:79], v[124:127], v[52:55], v[76:79]
  v_mfma_f32_16x16x32_bf16 v[80:83], v[140:143], v[52:55], v[80:83]
  v_mfma_f32_16x16x32_bf16 v[84:87], v[156:159], v[52:55], v[84:87]
  v_cmp_gt_u32 vcc, 2, v2
  s_nop 0
  s_and_saveexec_b64 s[62:63], vcc
  s_nop 1
  v_bfi_b32 v72, v248, s51, v72
  v_bfi_b32 v73, v248, s76, v73
  v_bfi_b32 v74, v248, s77, v74
  v_bfi_b32 v75, v248, s78, v75
  v_add_u32 v39, s72, v71
  ds_write_b128 v39, v[72:75]
  v_bfi_b32 v76, v248, s51, v76
  v_bfi_b32 v77, v248, s76, v77
  v_bfi_b32 v78, v248, s77, v78
  v_bfi_b32 v79, v248, s78, v79
  v_add_u32 v39, s73, v71
  ds_write_b128 v39, v[76:79]
  v_bfi_b32 v80, v248, s51, v80
  v_bfi_b32 v81, v248, s76, v81
  v_bfi_b32 v82, v248, s77, v82
  v_bfi_b32 v83, v248, s78, v83
  v_add_u32 v39, s74, v71
  ds_write_b128 v39, v[80:83]
  v_bfi_b32 v84, v248, s51, v84
  v_bfi_b32 v85, v248, s76, v85
  v_bfi_b32 v86, v248, s77, v86
  v_bfi_b32 v87, v248, s78, v87
  v_add_u32 v39, s75, v71
  ds_write_b128 v39, v[84:87]
  s_mov_b64 exec, s[62:63]
  s_waitcnt lgkmcnt(0)
  s_barrier
  s_cmp_lt_u32 s44, 4
  s_cbranch_scc0 L_skip_30
  ds_read_b128 v[72:75], v90
  s_waitcnt lgkmcnt(0)
  buffer_store_dwordx4 v[72:75], v36, s[32:35], s70 offen sc1
L_skip_30:
  s_cmp_eq_u32 s44, 7
  s_cbranch_scc0 L_fin
  s_lshr_b32 s71, s61, 6
  s_and_b32 s72, s61, 63
  v_lshrrev_b32 v36, 1, v1
  v_lshlrev_b32 v36, 12, v36
  v_and_b32 v37, 1, v1
  v_lshl_add_u32 v36, v37, 4, v36
  s_lshl_b32 s54, s71, 11
  s_lshl_b32 s55, s72, 5
  s_add_u32 s56, s54, s55
  v_lshlrev_b32 v37, 2, v37
  v_add_u32 v37, v37, v3
  v_lshlrev_b32 v202, 1, v37
  s_lshl_b32 s54, s71, 10
  s_lshl_b32 s55, s72, 4
  s_add_u32 s73, s54, s55
  s_mov_b32 s36, s4
  s_mov_b32 s37, s5
  s_mov_b32 s38, 2048
  s_mov_b32 s39, 0x20000
  buffer_load_ushort v201, v202, s[36:39], s73 offen
  s_add_u32 s54, s56, 917504
  s_add_u32 s66, s54, 131072
  s_add_u32 s67, s54, 262144
  s_add_u32 s68, s54, 393216
  v_mov_b32 v52, 0
  v_mov_b32 v53, 0
  v_mov_b32 v54, 0
  v_mov_b32 v55, 0
  v_cmp_gt_u32 s[74:75], 32, v1
  s_mov_b32 s60, 20000
  s_mov_b64 s[62:63], exec
L_hy_31:
  buffer_load_dwordx4 v[40:43], v36, s[32:35], s54 offen sc1
  buffer_load_dwordx4 v[44:47], v36, s[32:35], s66 offen sc1
  buffer_load_dwordx4 v[48:51], v36, s[32:35], s67 offen sc1
  s_mov_b64 s[76:77], exec
  s_and_b64 exec, exec, s[74:75]
  s_cbranch_execz L_y4_32
  buffer_load_dwordx4 v[52:55], v36, s[32:35], s68 offen sc1
L_y4_32:
  s_mov_b64 exec, s[76:77]
  s_waitcnt vmcnt(0)
  v_perm_b32 v252, v41, v40, s64
  v_perm_b32 v253, v43, v42, s65
  v_or_b32 v252, v252, v253
  v_xor_b32 v72, s51, v252
  v_perm_b32 v252, v45, v44, s64
  v_perm_b32 v253, v47, v46, s65
  v_or_b32 v252, v252, v253
  v_xor_b32 v252, s51, v252
  v_or_b32 v72, v72, v252
  v_perm_b32 v252, v49, v48, s64
  v_perm_b32 v253, v51, v50, s65
  v_or_b32 v252, v252, v253
  v_xor_b32 v252, s51, v252
  v_or_b32 v72, v72, v252
  v_cmp_ne_u32 vcc, 0, v72
  v_perm_b32 v252, v53, v52, s64
  v_perm_b32 v253, v55, v54, s65
  v_or_b32 v252, v252, v253
  v_xor_b32 v252, s51, v252
  v_cndmask_b32 v252, 0, v252, s[74:75]
  v_or_b32 v72, v72, v252
  v_cmp_ne_u32 vcc, 0, v72
  s_nop 0
  s_and_b64 vcc, vcc, exec
  s_cbranch_vccz L_done_33
  s_sub_u32 s60, s60, 1
  s_cbranch_scc1 L_done_33
  s_mov_b64 exec, vcc
  s_sleep 2
  s_branch L_hy_31
L_done_33:
  s_mov_b64 exec, s[62:63]
  v_add_f32 v40, v40, v44
  v_add_f32 v48, v48, v52
  v_add_f32 v41, v41, v45
  v_add_f32 v49, v49, v53
  v_add_f32 v42, v42, v46
  v_add_f32 v50, v50, v54
  v_add_f32 v43, v43, v47
  v_add_f32 v51, v51, v55
  v_add_f32 v40, v40, v48
  v_add_f32 v41, v41, v49
  v_add_f32 v42, v42, v50
  v_add_f32 v43, v43, v51
  s_nop 0
  v_permlane32_swap_b32 v40, v42
  v_permlane32_swap_b32 v41, v43
  v_add_f32 v40, v40, v42
  v_add_f32 v41, v41, v43
  s_nop 1
  v_permlane16_swap_b32 v40, v41
  v_add_f32 v40, v40, v41
  s_nop 1
  v_add_f32_dpp v40, v40, v40 row_ror:8 row_mask:0xf bank_mask:0xf
  s_nop 1
  v_add_f32_dpp v40, v40, v40 row_ror:4 row_mask:0xf bank_mask:0xf
  s_nop 1
  v_add_f32_dpp v40, v40, v40 row_ror:2 row_mask:0xf bank_mask:0xf
  v_mul_f32 v41, 0xbfb8aa3b, v40
  v_exp_f32 v41, v41
  s_nop 0
  v_add_f32 v41, 1.0, v41
  v_rcp_f32 v41, v41
  s_nop 0
  v_mul_f32 v200, v40, v41
  s_add_u32 s54, s56, 1572864
  s_add_u32 s66, s54, 131072
  s_add_u32 s67, s54, 262144
  s_add_u32 s68, s54, 393216
  s_mov_b32 s36, s24
  s_mov_b32 s37, s25
  s_mov_b32 s38, 2048
  s_mov_b32 s39, 0x20000
  v_lshlrev_b32 v201, 16, v201
  s_mov_b32 s60, 20000
  s_mov_b64 s[62:63], exec
L_h5_34:
  buffer_load_dwordx4 v[40:43], v36, s[32:35], s54 offen sc1
  buffer_load_dwordx4 v[44:47], v36, s[32:35], s66 offen sc1
  buffer_load_dwordx4 v[48:51], v36, s[32:35], s67 offen sc1
  buffer_load_dwordx4 v[52:55], v36, s[32:35], s68 offen sc1
  s_waitcnt vmcnt(0)
  v_perm_b32 v252, v41, v40, s64
  v_perm_b32 v253, v43, v42, s65
  v_or_b32 v252, v252, v253
  v_xor_b32 v72, s51, v252
  v_perm_b32 v252, v45, v44, s64
  v_perm_b32 v253, v47, v46, s65
  v_or_b32 v252, v252, v253
  v_xor_b32 v252, s51, v252
  v_or_b32 v72, v72, v252
  v_perm_b32 v252, v49, v48, s64
  v_perm_b32 v253, v51, v50, s65
  v_or_b32 v252, v252, v253
  v_xor_b32 v252, s51, v252
  v_or_b32 v72, v72, v252
  v_perm_b32 v252, v53, v52, s64
  v_perm_b32 v253, v55, v54, s65
  v_or_b32 v252, v252, v253
  v_xor_b32 v252, s51, v252
  v_or_b32 v72, v72, v252
  v_cmp_ne_u32 vcc, 0, v72
  s_nop 0
  s_and_b64 vcc, vcc, exec
  s_cbranch_vccz L_done_35
  s_sub_u32 s60, s60, 1
  s_cbranch_scc1 L_done_35
  s_mov_b64 exec, vcc
  s_sleep 2
  s_branch L_h5_34
L_done_35:
  s_mov_b64 exec, s[62:63]
  v_add_f32 v40, v40, v44
  v_add_f32 v48, v48, v52
  v_add_f32 v41, v41, v45
  v_add_f32 v49, v49, v53
  v_add_f32 v42, v42, v46
  v_add_f32 v50, v50, v54
  v_add_f32 v43, v43, v47
  v_add_f32 v51, v51, v55
  v_add_f32 v40, v40, v48
  v_add_f32 v41, v41, v49
  v_add_f32 v42, v42, v50
  v_add_f32 v43, v43, v51
  s_nop 0
  v_permlane32_swap_b32 v40, v42
  v_permlane32_swap_b32 v41, v43
  v_add_f32 v40, v40, v42
  v_add_f32 v41, v41, v43
  s_nop 1
  v_permlane16_swap_b32 v40, v41
  v_add_f32 v40, v40, v41
  s_nop 1
  v_add_f32_dpp v40, v40, v40 row_ror:8 row_mask:0xf bank_mask:0xf
  s_nop 1
  v_add_f32_dpp v40, v40, v40 row_ror:4 row_mask:0xf bank_mask:0xf
  s_nop 1
  v_add_f32_dpp v40, v40, v40 row_ror:2 row_mask:0xf bank_mask:0xf
  v_and_b32 v37, 14, v1
  v_cmp_eq_u32 vcc, 0, v37
  v_fmac_f32 v201, v40, v200
  v_cvt_pk_bf16_f32 v201, v201, v201
  s_and_saveexec_b64 s[62:63], vcc
  buffer_store_short v201, v202, s[36:39], s73 offen
  s_mov_b64 exec, s[62:63]
  s_add_u32 s54, s71, s72
  s_cmp_eq_u32 s54, 0
  s_cbranch_scc0 L_fin
  v_mov_b32 v37, s51
  v_mov_b32 v38, 0
  v_cmp_eq_u32 vcc, 0, v1
  s_nop 0
  s_and_saveexec_b64 s[62:63], vcc
  buffer_store_dword v37, v38, s[32:35], 0 offen sc1
  s_mov_b64 exec, s[62:63]
L_fin:
L_end:
  s_endpgm

.section .rodata,"a"
.p2align 6
.amdhsa_kernel recurrent_scan__compressed_kv_cla__glu_gated_reglu__decode_kernel
  .amdhsa_next_free_vgpr 256
  .amdhsa_next_free_sgpr 102
  .amdhsa_accum_offset 256
  .amdhsa_group_segment_fixed_size 0
  .amdhsa_kernarg_size 104
  .amdhsa_user_sgpr_count 2
  .amdhsa_user_sgpr_kernarg_segment_ptr 1
  .amdhsa_system_sgpr_workgroup_id_x 1
.end_amdhsa_kernel
```
